```python
import torch

def _softmax(x, axis=-1):
    return torch.softmax(x, dim=axis)
def _gelu(x):
    return torch.nn.functional.gelu(x, approximate="tanh")
def _silu(x):
    return torch.nn.functional.silu(x)
def _sigmoid(x):
    return torch.sigmoid(x)
def _layernorm(x, axis=-1, eps=1e-5):
    m = x.mean(dim=axis, keepdim=True)
    v = x.var(dim=axis, keepdim=True, unbiased=False)
    return (x - m) / torch.sqrt(v + eps)
def _scatter_add(tgt, idx, src, axis=0):
    return tgt.clone().index_add_(axis, idx, src)
def _segment_sum(src, seg, n):
    out = torch.zeros((n,) + src.shape[1:], dtype=src.dtype)
    return out.index_add_(0, seg, src)
def _pad(x, pw):
    flat = tuple(v for pair in reversed(pw) for v in pair)
    return torch.nn.functional.pad(x, flat)

kernel_name = 'gated_mix__spectral_gfnet__linear_attn_block__prompt'

def setup_inputs():

    _w = (lambda a: (lambda t: t.to(torch.bfloat16) if t.is_floating_point() else t)(torch.as_tensor(a)))
    def _A_setup():
        B, S, D = 1, 2048, 512
        Df = D // 2 + 1
        return {
            "x": _w((lambda *s: torch.randn(*s, dtype=torch.bfloat16) * 0.05)(B, S, D)),
            "w_r": _w((lambda *s: torch.randn(*s, dtype=torch.bfloat16) * 1.6)(S, Df) * 0.02),
            "w_i": _w((lambda *s: torch.randn(*s, dtype=torch.bfloat16) * 1.6)(S, Df) * 0.02),
        }
    _A_in = _A_setup()

    def _B_setup():
        B, S, D = 1, 2048, 512
        return {
            "x": _w((lambda *s: torch.randn(*s, dtype=torch.bfloat16) * 0.05)(B, S, D)),
            "wqkv": _w((lambda *s: torch.randn(*s, dtype=torch.bfloat16) * 0.4)(D, 3 * D)),
            "wo": _w((lambda *s: torch.randn(*s, dtype=torch.bfloat16) * 0.05)(D, D)),
        }
    _B_in = _B_setup()

    return {
        "A_x": _A_in["x"],
        "A_w_r": _A_in["w_r"],
        "A_w_i": _A_in["w_i"],
        "B_x": _B_in["x"],
        "B_wqkv": _B_in["wqkv"],
        "B_wo": _B_in["wo"],
        "gate_w": _w((lambda *s: torch.randn(*s, dtype=torch.bfloat16) * 0.05)(512) * 16.0),
    }

def reference(A_x, A_w_r, A_w_i, B_x, B_wqkv, B_wo, gate_w):
    def _A_ref(x, w_r, w_i):
        B, S, D = x.shape
        X = (lambda x, axes=(-2,-1): torch.fft.rfft2(x.float(), dim=axes))(x, axes=(-2, -1))
        W = w_r + 1j * w_i
        X = X * W
        y = (lambda x, s, axes=(-2,-1): torch.fft.irfft2(x, s=s, dim=axes).to(torch.bfloat16))(X, (S, D), axes=(-2, -1))
        return y

    def _B_ref(x, wqkv, wo):
        B, S, D = x.shape
        H = 32; Dh = D // H
        qkv = (lambda x, *d: x.permute(*d))((x @ wqkv).reshape(B, S, 3, H, Dh), 2, 0, 3, 1, 4)
        q, k, v = qkv[0], qkv[1], qkv[2]
        phi = lambda t: torch.where(t > 0, t + 1, torch.exp(t)) + 1e-6
        pq, pk = phi(q), phi(k)
        kv = torch.einsum("bhsd,bhse->bhde", pk, v)
        z = torch.einsum("bhsd->bhd", pk)
        num = torch.einsum("bhqd,bhde->bhqe", pq, kv)
        den = torch.einsum("bhqd,bhd->bhq", pq, z)[..., None] + 1e-6
        o = num / den
        return (lambda x, *d: x.permute(*d))(o, 0, 2, 1, 3).reshape(B, S, D) @ wo

    x = A_x
    g = _sigmoid((x * gate_w).sum(-1, keepdims=True))
    a = _A_ref(x, A_w_r, A_w_i)
    b = _B_ref(x, B_wqkv, B_wo)
    return g * a + (1 - g) * b
```

```asm
; @launch grid=(256,1,1) block=(768,1,1) lds=163840
.amdgcn_target "amdgcn-amd-amdhsa--gfx950"
.text
.set CODE_LINES, (Lcode_end - gated_mix__spectral_gfnet__linear_attn_block__prompt_kernel + 127) / 128 - 1
.set PF_PER, 5
.globl gated_mix__spectral_gfnet__linear_attn_block__prompt_kernel
.p2align 8
.type gated_mix__spectral_gfnet__linear_attn_block__prompt_kernel,@function
gated_mix__spectral_gfnet__linear_attn_block__prompt_kernel:
    s_cmp_ge_u32 s2, 256
    s_cbranch_scc1 Lend
    s_load_dwordx16 s[4:19], s[0:1], 0
    s_load_dwordx4 s[20:23], s[0:1], 64
    s_getpc_b64 s[98:99]
    s_lshr_b32 s29, s2, 3
    s_mul_i32 s30, s29, PF_PER
    v_add_u32 v10, s30, v0
    v_min_u32 v10, CODE_LINES, v10
    v_lshlrev_b32 v10, 7, v10
    v_mov_b32 v11, s99
    v_add_co_u32 v10, vcc, s98, v10
    s_nop 1
    v_addc_co_u32 v11, vcc, 0, v11, vcc
    v_cmp_gt_u32 vcc, PF_PER, v0
    s_nop 0
    s_and_saveexec_b64 s[98:99], vcc
    s_cbranch_execz Lpf_skip
    global_load_dword v9, v[10:11], off
Lpf_skip:
    s_mov_b64 exec, -1
    v_lshrrev_b32 v7, 6, v0
    v_and_b32 v5, 63, v0
    v_readfirstlane_b32 s24, v7
    v_and_b32 v6, 15, v0
    v_bfe_u32 v7, v0, 4, 2
    v_lshlrev_b32 v8, 4, v5
    v_mov_b32 v3, 139264
    v_mov_b32 v4, 1
    s_and_b32 s28, s2, 7
    s_lshr_b32 s25, s28, 1
    s_lshl_b32 s25, s25, 3
    s_lshr_b32 s31, s29, 2
    s_add_u32 s25, s25, s31
    s_and_b32 s26, s28, 1
    s_lshl_b32 s26, s26, 2
    s_and_b32 s30, s29, 3
    s_add_u32 s26, s26, s30
    s_lshl_b32 s27, s25, 3
    s_add_u32 s27, s27, s26
    s_mov_b32 s32, 40000
    s_mov_b32 s3, 1
    s_cmp_lt_u32 s24, 8
    s_cbranch_scc1 Lcompute
    s_setprio 3
    s_cmp_ge_u32 s24, 10
    s_cbranch_scc1 Laux
    s_add_u32 s37, s31, s30
    s_lshr_b32 s40, s28, 1
    s_mul_i32 s40, s40, 2
    s_and_b32 s33, s24, 1
    s_lshl_b32 s30, s33, 2
    v_add_u32 v1, s30, v7
    v_xor_b32 v1, v1, v5
    v_and_b32 v1, 7, v1
    v_lshrrev_b32 v2, 3, v5
    v_lshlrev_b32 v10, 10, v2
    v_lshl_add_u32 v10, v1, 4, v10
    s_lshl_b32 s31, s33, 5
    s_add_u32 s31, s31, s25
    s_lshl_b32 s31, s31, 13
    v_add_u32 v10, s31, v10
    v_and_b32 v1, 1, v7
    v_lshl_or_b32 v1, v1, 1, s30
    v_xor_b32 v1, v1, v5
    v_and_b32 v1, 7, v1
    v_mul_u32_u24 v11, 3072, v2
    v_lshl_add_u32 v11, v1, 4, v11
    s_mul_i32 s31, s33, 24576
    s_lshl_b32 s30, s26, 7
    s_add_u32 s31, s31, s30
    v_add_u32 v11, s31, v11
    v_xor_b32 v12, 256, v11
    s_lshl_b32 s34, s33, 10
    s_mov_b32 s39, 0
    s_lshl_b32 s31, s33, 8
    s_add_u32 s31, s31, s27
    s_lshl_b32 s31, s31, 10
    s_add_u32 m0, s34, 131072
    s_waitcnt lgkmcnt(0)
    s_mov_b32 s44, s4
    s_mov_b32 s45, s5
    s_mov_b32 s46, 2097152
    s_mov_b32 s47, 0x20000
    buffer_load_dwordx4 v8, s[44:47], s31 offen lds
    s_add_u32 m0, m0, 2048
    s_add_u32 s31, s31, 524288
    buffer_load_dwordx4 v8, s[44:47], s31 offen lds
    s_add_u32 m0, m0, 2048
    s_add_u32 s31, s31, 524288
    buffer_load_dwordx4 v8, s[44:47], s31 offen lds
    s_add_u32 m0, m0, 2048
    s_add_u32 s31, s31, 524288
    buffer_load_dwordx4 v8, s[44:47], s31 offen lds
    s_mov_b32 s48, s12
    s_mov_b32 s49, s13
    s_mov_b32 s50, 1572864
    s_mov_b32 s51, 0x20000
Lchunk:
    s_add_u32 s30, s37, s39
    s_and_b32 s30, s30, 1
    s_add_u32 s31, s39, s40
    s_and_b32 s31, s31, 6
    s_or_b32 s30, s30, s31
    s_lshl_b32 s35, s30, 7
    s_mul_i32 s36, s30, 196608
    s_and_b32 s30, s39, 3
    s_lshl_b32 s30, s30, 15
    s_add_u32 m0, s30, s34
    s_add_u32 s39, s39, 1
    buffer_load_dwordx4 v12, s[48:51], s36 offen lds
    s_add_u32 m0, m0, 2048
    s_add_u32 s36, s36, 49152
    buffer_load_dwordx4 v12, s[48:51], s36 offen lds
    s_add_u32 m0, m0, 2048
    s_add_u32 s36, s36, 49152
    buffer_load_dwordx4 v12, s[48:51], s36 offen lds
    s_add_u32 m0, m0, 2048
    s_add_u32 s36, s36, 49152
    buffer_load_dwordx4 v12, s[48:51], s36 offen lds
    s_add_u32 m0, m0, 2048
    s_add_u32 s36, s36, 4294820864
    buffer_load_dwordx4 v11, s[48:51], s36 offen lds
    s_add_u32 m0, m0, 2048
    s_add_u32 s36, s36, 49152
    buffer_load_dwordx4 v11, s[48:51], s36 offen lds
    s_add_u32 m0, m0, 2048
    s_add_u32 s36, s36, 49152
    buffer_load_dwordx4 v11, s[48:51], s36 offen lds
    s_add_u32 m0, m0, 2048
    s_add_u32 s36, s36, 49152
    buffer_load_dwordx4 v11, s[48:51], s36 offen lds
    s_add_u32 m0, m0, 2048
    s_add_u32 s36, s36, 4294820864
    buffer_load_dwordx4 v11, s[48:51], s36 offen lds
    s_add_u32 m0, m0, 2048
    s_add_u32 s36, s36, 49152
    buffer_load_dwordx4 v11, s[48:51], s36 offen lds
    s_add_u32 m0, m0, 2048
    s_add_u32 s36, s36, 49152
    buffer_load_dwordx4 v11, s[48:51], s36 offen lds
    s_add_u32 m0, m0, 2048
    s_add_u32 s36, s36, 49152
    buffer_load_dwordx4 v11, s[48:51], s36 offen lds
    s_add_u32 m0, m0, 2048
    s_cmp_lg_u32 s39, 1
    s_cbranch_scc1 Lt0_skip
    s_barrier
Lt0_skip:
    buffer_load_dwordx4 v10, s[44:47], s35 offen lds
    s_add_u32 m0, m0, 2048
    s_add_u32 s35, s35, 524288
    buffer_load_dwordx4 v10, s[44:47], s35 offen lds
    s_add_u32 m0, m0, 2048
    s_add_u32 s35, s35, 524288
    buffer_load_dwordx4 v10, s[44:47], s35 offen lds
    s_add_u32 m0, m0, 2048
    s_add_u32 s35, s35, 524288
    buffer_load_dwordx4 v10, s[44:47], s35 offen lds
    s_cmp_lt_u32 s39, 8
    s_waitcnt vmcnt(16)
    s_barrier
    s_cbranch_scc1 Lchunk
    s_branch Lloader2
Laux:
    v_mov_b32 v2, 0
    s_cmp_eq_u32 s24, 10
    s_cbranch_scc0 Laux1e
    v_lshl_add_u32 v1, v6, 2, v3
    ds_write_b32 v1, v2
    s_mov_b32 m0, 155904
    s_cmp_lg_u32 s2, 0
    s_waitcnt lgkmcnt(0)
    global_load_lds_dwordx4 v8, s[16:17]
    s_cbranch_scc1 Lnonce_skip
    s_memrealtime s[98:99]
    s_waitcnt lgkmcnt(0)
    s_or_b32 s30, s98, 1
    v_mov_b32 v1, s30
    s_mov_b64 exec, 1
    global_store_dword v2, v1, s[20:21] sc1
    s_mov_b64 exec, -1
Lnonce_skip:
    s_barrier
    s_branch Laux0
Laux1e:
    v_lshrrev_b32 v1, 3, v5
    s_lshl_b32 s30, s27, 3
    v_add_u32 v1, s30, v1
    v_sub_u32 v2, 2048, v1
    v_and_b32 v2, 2047, v2
    s_mov_b32 vcc_lo, 0xcccccccc
    s_mov_b32 vcc_hi, 0xcccccccc
    v_cndmask_b32 v1, v1, v2, vcc
    v_mul_u32_u24 v1, 514, v1
    v_and_b32 v2, 4, v5
    v_lshl_add_u32 v10, v2, 7, v1
    s_mov_b32 exec_lo, 0x55555555
    s_mov_b32 exec_hi, 0x55555555
    s_waitcnt lgkmcnt(0)
    global_load_ushort v11, v10, s[6:7]
    s_not_b64 exec, exec
    global_load_ushort v11, v10, s[8:9]
    s_mov_b64 exec, -1
    s_barrier
    s_branch Laux1
Lcompute:
    s_lshl_b32 s33, s24, 10
    s_add_u32 m0, s33, 131072
    s_and_b32 s34, s24, 3
    s_lshr_b32 s35, s24, 2
    v_add_u32 v24, 98304, v8
    v_cvt_f32_u32 v25, v6
    v_lshlrev_b32 v46, 2, v7
    v_cvt_f32_u32 v46, v46
    v_add_f32 v47, 1.0, v46
    v_add_f32 v48, 2.0, v46
    v_add_f32 v49, 2.0, v47
    v_mul_f32 v50, v46, v25
    v_mul_f32 v51, v47, v25
    v_mul_f32 v52, v48, v25
    v_mul_f32 v53, v49, v25
    s_cmp_eq_u32 s24, 1
    s_cbranch_scc1 Lg1
    s_cmp_eq_u32 s24, 2
    s_cbranch_scc1 Lg2
    s_cmp_eq_u32 s24, 3
    s_cbranch_scc1 Lg3
    s_cmp_eq_u32 s24, 4
    s_cbranch_scc1 Lg4
    s_cmp_eq_u32 s24, 5
    s_cbranch_scc1 Lg5
    s_cmp_eq_u32 s24, 6
    s_cbranch_scc1 Lg6
    s_cmp_eq_u32 s24, 7
    s_cbranch_scc1 Lg7
    v_mul_f32 v58, 0x3d000000, v50
    v_mul_f32 v59, 0x3d000000, v51
    v_mul_f32 v60, 0x3d000000, v52
    v_mul_f32 v61, 0x3d000000, v53
    v_cos_f32 v54, v58
    v_cos_f32 v55, v59
    v_cos_f32 v56, v60
    v_cos_f32 v57, v61
    v_sin_f32 v58, v58
    v_sin_f32 v59, v59
    v_sin_f32 v60, v60
    v_sin_f32 v61, v61
    v_lshlrev_b32 v1, 31, v6
    v_lshrrev_b32 v2, 16, v1
    v_or_b32 v1, v1, v2
    v_cvt_pk_bf16_f32 v62, v54, v55
    v_cvt_pk_bf16_f32 v63, v56, v57
    v_cvt_pk_bf16_f32 v66, -v58, -v59
    v_cvt_pk_bf16_f32 v67, -v60, -v61
    s_mov_b32 exec_lo, 0x00010001
    s_mov_b32 exec_hi, 0x00010001
    v_mov_b32 v66, 0xbf803f80
    v_mov_b32 v67, 0xbf803f80
    s_mov_b64 exec, -1
    v_xor_b32 v64, v62, v1
    v_xor_b32 v65, v63, v1
    v_xor_b32 v68, v66, v1
    v_xor_b32 v69, v67, v1
    ds_write_b128 v24, v[62:65] offset:0
    ds_write_b128 v24, v[66:69] offset:1024
    s_branch Lgj
Lg1:
    v_mul_f32 v58, 0x3b000000, v50
    v_mul_f32 v59, 0x3b000000, v51
    v_mul_f32 v60, 0x3b000000, v52
    v_mul_f32 v61, 0x3b000000, v53
    v_cos_f32 v54, v58
    v_cos_f32 v55, v59
    v_cos_f32 v56, v60
    v_cos_f32 v57, v61
    v_sin_f32 v58, v58
    v_sin_f32 v59, v59
    v_sin_f32 v60, v60
    v_sin_f32 v61, v61
    s_nop 0
    ds_write_b128 v24, v[54:57] offset:2048
    ds_write_b128 v24, v[58:61] offset:3072
    s_branch Lgj
Lg2:
    v_cmp_gt_u32 vcc, 8, v6
    v_sub_f32 v1, 0x41b80000, v25
    s_nop 0
    v_cndmask_b32 v1, v1, v25, vcc
    v_mul_f32 v1, 0x3d800000, v1
    v_mul_f32 v58, v1, v46
    v_mul_f32 v59, v1, v47
    v_mul_f32 v60, v1, v48
    v_mul_f32 v61, v1, v49
    v_cos_f32 v54, v58
    v_cos_f32 v55, v59
    v_cos_f32 v56, v60
    v_cos_f32 v57, v61
    v_sin_f32 v58, v58
    v_sin_f32 v59, v59
    v_sin_f32 v60, v60
    v_sin_f32 v61, v61
    v_mov_b32 v2, 0x80008000
    v_cndmask_b32_e64 v2, v2, 0, vcc
    v_cvt_pk_bf16_f32 v62, v54, v58
    v_cvt_pk_bf16_f32 v63, v55, v59
    v_cvt_pk_bf16_f32 v64, v56, v60
    v_cvt_pk_bf16_f32 v65, v57, v61
    v_cvt_pk_bf16_f32 v66, -v58, v54
    v_cvt_pk_bf16_f32 v67, -v59, v55
    v_cvt_pk_bf16_f32 v68, -v60, v56
    v_cvt_pk_bf16_f32 v69, -v61, v57
    v_xor_b32 v66, v66, v2
    v_xor_b32 v67, v67, v2
    v_xor_b32 v68, v68, v2
    v_xor_b32 v69, v69, v2
    ds_write_b128 v24, v[62:65] offset:4096
    ds_write_b128 v24, v[66:69] offset:5120
    s_branch Lgj
Lg3:
    v_cmp_gt_u32 vcc, 8, v6
    v_add_f32 v1, 0xc0f00000, v25
    s_nop 0
    v_cndmask_b32 v1, v1, v25, vcc
    v_mul_f32 v1, 0x3d800000, v1
    v_mul_f32 v58, v1, v46
    v_mul_f32 v59, v1, v47
    v_mul_f32 v60, v1, v48
    v_mul_f32 v61, v1, v49
    v_cos_f32 v54, v58
    v_cos_f32 v55, v59
    v_cos_f32 v56, v60
    v_cos_f32 v57, v61
    v_sin_f32 v58, v58
    v_sin_f32 v59, v59
    v_sin_f32 v60, v60
    v_sin_f32 v61, v61
    v_mov_b32 v2, 0xffff
    v_not_b32 v1, v2
    v_cndmask_b32 v2, v1, v2, vcc
    v_cvt_pk_bf16_f32 v62, v54, v54
    v_cvt_pk_bf16_f32 v63, v55, v55
    v_cvt_pk_bf16_f32 v64, v56, v56
    v_cvt_pk_bf16_f32 v65, v57, v57
    v_cvt_pk_bf16_f32 v66, -v58, -v58
    v_cvt_pk_bf16_f32 v67, -v59, -v59
    v_cvt_pk_bf16_f32 v68, -v60, -v60
    v_cvt_pk_bf16_f32 v69, -v61, -v61
    v_and_b32 v62, v62, v2
    v_and_b32 v63, v63, v2
    v_and_b32 v64, v64, v2
    v_and_b32 v65, v65, v2
    v_and_b32 v66, v66, v2
    v_and_b32 v67, v67, v2
    v_and_b32 v68, v68, v2
    v_and_b32 v69, v69, v2
    s_mov_b32 exec_lo, 0x00010001
    s_mov_b32 exec_hi, 0x00010001
    v_mov_b32 v66, 0x3f80
    v_mov_b32 v67, 0xbf80
    v_mov_b32 v68, 0x3f80
    v_mov_b32 v69, 0xbf80
    s_mov_b64 exec, -1
    ds_write_b128 v24, v[62:65] offset:6144
    ds_write_b128 v24, v[66:69] offset:7168
    s_branch Lgj
Lg4:
    v_mul_f32 v58, 0x3e000000, v50
    v_mul_f32 v59, 0x3e000000, v51
    v_mul_f32 v60, 0x3e000000, v52
    v_mul_f32 v61, 0x3e000000, v53
    v_cos_f32 v54, v58
    v_cos_f32 v55, v59
    v_cos_f32 v56, v60
    v_cos_f32 v57, v61
    v_sin_f32 v58, v58
    v_sin_f32 v59, v59
    v_sin_f32 v60, v60
    v_sin_f32 v61, v61
    v_lshrrev_b32 v1, 3, v6
    v_lshrrev_b32 v2, 1, v7
    v_cmp_eq_u32 vcc, v1, v2
    v_cvt_pk_bf16_f32 v62, v54, v58
    v_cvt_pk_bf16_f32 v63, v55, v59
    v_cvt_pk_bf16_f32 v64, v56, v60
    v_cvt_pk_bf16_f32 v65, v57, v61
    v_cvt_pk_bf16_f32 v66, -v58, v54
    v_cvt_pk_bf16_f32 v67, -v59, v55
    v_cvt_pk_bf16_f32 v68, -v60, v56
    v_cvt_pk_bf16_f32 v69, -v61, v57
    v_cndmask_b32 v62, 0, v62, vcc
    v_cndmask_b32 v63, 0, v63, vcc
    v_cndmask_b32 v64, 0, v64, vcc
    v_cndmask_b32 v65, 0, v65, vcc
    v_cndmask_b32 v66, 0, v66, vcc
    v_cndmask_b32 v67, 0, v67, vcc
    v_cndmask_b32 v68, 0, v68, vcc
    v_cndmask_b32 v69, 0, v69, vcc
    ds_write_b128 v24, v[62:65] offset:8192
    ds_write_b128 v24, v[66:69] offset:9216
    s_branch Lgj
Lg5:
    v_cvt_f32_u32 v1, s28
    v_mul_f32 v1, 0x3e000000, v1
    v_fma_f32 v70, v1, v46, v50
    v_fma_f32 v71, v1, v47, v51
    v_fma_f32 v72, v1, v48, v52
    v_fma_f32 v73, v1, v49, v53
    v_mul_f32 v58, 0x3d800000, v70
    v_mul_f32 v59, 0x3d800000, v71
    v_mul_f32 v60, 0x3d800000, v72
    v_mul_f32 v61, 0x3d800000, v73
    v_cos_f32 v54, v58
    v_cos_f32 v55, v59
    v_cos_f32 v56, v60
    v_cos_f32 v57, v61
    v_sin_f32 v58, v58
    v_sin_f32 v59, v59
    v_sin_f32 v60, v60
    v_sin_f32 v61, v61
    v_cvt_pk_bf16_f32 v62, v54, v58
    v_cvt_pk_bf16_f32 v63, v55, v59
    v_cvt_pk_bf16_f32 v64, v56, v60
    v_cvt_pk_bf16_f32 v65, v57, v61
    v_cvt_pk_bf16_f32 v66, -v58, v54
    v_cvt_pk_bf16_f32 v67, -v59, v55
    v_cvt_pk_bf16_f32 v68, -v60, v56
    v_cvt_pk_bf16_f32 v69, -v61, v57
    ds_write_b128 v24, v[62:65] offset:10240
    ds_write_b128 v24, v[66:69] offset:11264
    v_mul_f32 v58, 0x3b800000, v70
    v_mul_f32 v59, 0x3b800000, v71
    v_mul_f32 v60, 0x3b800000, v72
    v_mul_f32 v61, 0x3b800000, v73
    v_cos_f32 v54, v58
    v_cos_f32 v55, v59
    v_cos_f32 v56, v60
    v_cos_f32 v57, v61
    v_sin_f32 v58, v58
    v_sin_f32 v59, v59
    v_sin_f32 v60, v60
    v_sin_f32 v61, v61
    s_nop 0
    ds_write_b128 v24, v[54:57] offset:12288
    ds_write_b128 v24, v[58:61] offset:13312
    s_branch Lgj
Lg6:
    v_mul_f32 v58, 0x3d800000, v50
    v_mul_f32 v59, 0x3d800000, v51
    v_mul_f32 v60, 0x3d800000, v52
    v_mul_f32 v61, 0x3d800000, v53
    v_cos_f32 v54, v58
    v_cos_f32 v55, v59
    v_cos_f32 v56, v60
    v_cos_f32 v57, v61
    v_sin_f32 v58, v58
    v_sin_f32 v59, v59
    v_sin_f32 v60, v60
    v_sin_f32 v61, v61
    v_cvt_pk_bf16_f32 v62, v54, v58
    v_cvt_pk_bf16_f32 v63, v55, v59
    v_cvt_pk_bf16_f32 v64, v56, v60
    v_cvt_pk_bf16_f32 v65, v57, v61
    v_cvt_pk_bf16_f32 v66, -v58, v54
    v_cvt_pk_bf16_f32 v67, -v59, v55
    v_cvt_pk_bf16_f32 v68, -v60, v56
    v_cvt_pk_bf16_f32 v69, -v61, v57
    ds_write_b128 v24, v[62:65] offset:14336
    ds_write_b128 v24, v[66:69] offset:15360
    s_branch Lgj
Lg7:
    v_cvt_f32_u32 v1, s28
    v_mul_f32 v1, 0x3e000000, v1
    v_fma_f32 v70, v1, v25, v50
    v_fma_f32 v71, v1, v25, v51
    v_fma_f32 v72, v1, v25, v52
    v_fma_f32 v73, v1, v25, v53
    v_mul_f32 v58, 0x3d800000, v70
    v_mul_f32 v59, 0x3d800000, v71
    v_mul_f32 v60, 0x3d800000, v72
    v_mul_f32 v61, 0x3d800000, v73
    v_cos_f32 v54, v58
    v_cos_f32 v55, v59
    v_cos_f32 v56, v60
    v_cos_f32 v57, v61
    v_sin_f32 v58, v58
    v_sin_f32 v59, v59
    v_sin_f32 v60, v60
    v_sin_f32 v61, v61
    v_cvt_pk_bf16_f32 v62, v54, -v58
    v_cvt_pk_bf16_f32 v63, v55, -v59
    v_cvt_pk_bf16_f32 v64, v56, -v60
    v_cvt_pk_bf16_f32 v65, v57, -v61
    v_cvt_pk_bf16_f32 v66, v58, v54
    v_cvt_pk_bf16_f32 v67, v59, v55
    v_cvt_pk_bf16_f32 v68, v60, v56
    v_cvt_pk_bf16_f32 v69, v61, v57
    ds_write_b128 v24, v[62:65] offset:18432
    ds_write_b128 v24, v[66:69] offset:19456
    v_mul_f32 v58, 0x3b800000, v70
    v_mul_f32 v59, 0x3b800000, v71
    v_mul_f32 v60, 0x3b800000, v72
    v_mul_f32 v61, 0x3b800000, v73
    v_cos_f32 v54, v58
    v_cos_f32 v55, v59
    v_cos_f32 v56, v60
    v_cos_f32 v57, v61
    v_sin_f32 v58, v58
    v_sin_f32 v59, v59
    v_sin_f32 v60, v60
    v_sin_f32 v61, v61
    s_nop 0
    ds_write_b128 v24, v[54:57] offset:16384
    ds_write_b128 v24, v[58:61] offset:17408
Lgj:
    v_lshrrev_b32 v2, 1, v7
    v_and_b32 v1, 1, v7
    v_mul_u32_u24 v42, 1040, v1
    v_lshl_add_u32 v42, v2, 4, v42
    v_add_u32 v42, v42, v6
    s_lshl_b32 s30, s24, 7
    s_add_u32 s30, s30, 139392
    v_lshl_add_u32 v42, v42, 2, s30
    v_sub_u32 v2, 32, v6
    v_cmp_eq_u32 vcc, 0, v6
    s_nop 1
    v_cndmask_b32_e64 v2, v2, 16, vcc
    v_cmp_gt_u32 vcc, 2, v7
    s_nop 1
    v_cndmask_b32 v2, v2, v6, vcc
    v_lshl_add_u32 v1, v1, 7, v2
    s_mul_i32 s30, s24, 1040
    s_add_u32 s30, s30, 139392
    v_lshl_add_u32 v11, v1, 2, s30
    s_add_u32 s31, s33, 131072
    v_lshl_add_u32 v44, v5, 3, s31
    v_add_u32 v10, s31, v8
    v_and_b32 v1, 7, v6
    v_lshrrev_b32 v2, 3, v6
    v_lshl_add_u32 v1, v1, 4, v2
    v_mul_u32_u24 v43, 16512, v1
    v_lshl_add_u32 v43, v7, 4, v43
    s_mul_i32 s30, s24, 33024
    s_lshl_b32 s31, s27, 6
    s_add_u32 s30, s30, s31
    v_add_u32 v43, s30, v43
    s_waitcnt lgkmcnt(0)
    s_barrier
    ds_read_b128 v[62:65], v24 offset:0
    ds_read_b128 v[66:69], v24 offset:1024
    ds_read_b128 v[26:29], v24 offset:2048
    ds_read_b128 v[30:33], v24 offset:3072
    ds_read_b128 v[70:73], v24 offset:4096
    ds_read_b128 v[74:77], v24 offset:5120
    ds_read_b128 v[78:81], v24 offset:6144
    ds_read_b128 v[82:85], v24 offset:7168
    ds_read_b128 v[34:37], v24 offset:8192
    ds_read_b128 v[38:41], v24 offset:9216
    ds_read_b128 v[46:49], v24 offset:10240
    ds_read_b128 v[50:53], v24 offset:11264
    ds_read_b128 v[86:89], v24 offset:12288
    ds_read_b128 v[90:93], v24 offset:13312
    ds_read_b128 v[94:97], v24 offset:14336
    ds_read_b128 v[98:101], v24 offset:15360
    ds_read_b128 v[102:105], v24 offset:16384
    ds_read_b128 v[106:109], v24 offset:17408
    ds_read_b128 v[110:113], v24 offset:18432
    ds_read_b128 v[114:117], v24 offset:19456
    v_lshrrev_b32 v2, 3, v6
    v_lshrrev_b32 v1, 1, v6
    v_xor_b32 v1, v1, v7
    v_lshlrev_b32 v1, 4, v1
    v_lshl_add_u32 v1, v6, 7, v1
    s_lshl_b32 s31, s35, 12
    v_add_u32 v18, s31, v1
    v_xor_b32 v19, 64, v18
    v_and_b32 v1, 1, v7
    v_lshl_or_b32 v1, v1, 1, v2
    v_xor_b32 v1, s34, v1
    v_lshlrev_b32 v1, 5, v1
    v_and_b32 v2, 3, v6
    v_lshl_add_u32 v1, v2, 3, v1
    v_lshrrev_b32 v2, 2, v6
    v_lshl_add_u32 v2, v7, 3, v2
    v_lshl_add_u32 v20, v2, 7, v1
    v_add_u32 v21, 0x10000, v18
    v_add_u32 v22, 0x10000, v19
    v_add_u32 v23, 0x10000, v20
    s_xor_b32 s30, s26, 2
    s_lshl_b32 s30, s30, 2
    s_add_u32 s30, s30, s34
    s_lshl_b32 s31, s25, 1
    s_add_u32 s31, s31, s35
    s_lshl_b32 s31, s31, 5
    s_add_u32 s31, s31, s30
    s_lshl_b32 s31, s31, 10
    s_add_u32 s31, s31, 6291456
    v_add_u32 v15, s31, v8
    s_add_u32 s30, s33, 139392
    v_add_u32 v16, s30, v8
    s_lshl_b32 s30, s24, 6
    s_add_u32 s30, s30, 162048
    v_lshl_add_u32 v17, v7, 4, s30
    s_or_b32 s36, s29, s24
    v_lshl_add_u32 v1, v7, 6, v6
    v_bfe_u32 v2, v6, 2, 1
    v_xor_b32 v2, s35, v2
    v_lshl_add_u32 v2, v1, 1, v2
    s_lshl_b32 s31, s34, 2
    s_add_u32 s31, s31, 131072
    v_lshl_add_u32 v12, v2, 4, s31
    s_lshl_b32 s31, s24, 1
    s_add_u32 s31, s31, 147712
    v_lshl_add_u32 v13, v1, 4, s31
    v_lshrrev_b32 v1, 3, v0
    v_xor_b32 v1, v1, v0
    v_and_b32 v1, 1, v1
    v_and_b32 v2, 2, v0
    v_or_b32 v1, v1, v2
    v_lshrrev_b32 v2, 2, v0
    v_lshl_add_u32 v1, v2, 3, v1
    s_lshl_b32 s30, s28, 4
    s_lshr_b32 s31, s29, 1
    s_add_u32 s30, s30, s31
    s_mul_i32 s30, s30, 16512
    s_and_b32 s31, s29, 1
    s_lshl_b32 s31, s31, 6
    s_add_u32 s30, s30, s31
    v_lshl_add_u32 v14, v1, 4, s30
    s_mov_b32 s40, 0x3fb8aa3b
    s_mov_b32 s41, 0x3fb8aa3b
    s_mov_b32 s42, 0x358637bd
    s_mov_b32 s43, 0x358637bd
    s_waitcnt lgkmcnt(0)
    s_barrier
    ds_read_b64_tr_b16 v[118:119], v44
    ds_read_b64_tr_b16 v[120:121], v44 offset:512
    s_waitcnt lgkmcnt(0)
    v_mfma_f32_16x16x32_bf16 v[122:125], v[118:121], v[62:65], 0
    v_mfma_f32_16x16x32_bf16 v[126:129], v[118:121], v[66:69], 0
    s_nop 6
    v_pk_mul_f32 v[164:165], v[122:123], v[26:27]
    v_pk_mul_f32 v[166:167], v[124:125], v[28:29]
    v_pk_mul_f32 v[160:161], v[122:123], v[30:31] neg_lo:[1,0] neg_hi:[1,0]
    v_pk_mul_f32 v[162:163], v[124:125], v[32:33] neg_lo:[1,0] neg_hi:[1,0]
    v_pk_fma_f32 v[164:165], v[126:127], v[30:31], v[164:165]
    v_pk_fma_f32 v[160:161], v[126:127], v[26:27], v[160:161]
    v_pk_fma_f32 v[166:167], v[128:129], v[32:33], v[166:167]
    v_pk_fma_f32 v[162:163], v[128:129], v[28:29], v[162:163]
    v_cvt_pk_bf16_f32 v118, v164, v160
    v_cvt_pk_bf16_f32 v119, v165, v161
    v_cvt_pk_bf16_f32 v120, v166, v162
    v_cvt_pk_bf16_f32 v121, v167, v163
    s_nop 1
    v_mfma_f32_16x16x32_bf16 v[122:125], v[70:73], v[118:121], 0
    v_mfma_f32_16x16x32_bf16 v[126:129], v[74:77], v[118:121], 0
    v_mfma_f32_16x16x32_bf16 v[54:57], v[78:81], v[118:121], 0
    v_mfma_f32_16x16x32_bf16 v[58:61], v[82:85], v[118:121], 0
    s_nop 5
    v_cvt_pk_bf16_f32 v118, v122, v126
    v_cvt_pk_bf16_f32 v119, v123, v127
    v_cvt_pk_bf16_f32 v120, v124, v128
    v_cvt_pk_bf16_f32 v121, v125, v129
    s_mov_b32 exec_lo, 0x00010001
    s_mov_b32 exec_hi, 0x00010001
    v_cvt_pk_bf16_f32 v118, v54, v58
    v_cvt_pk_bf16_f32 v119, v55, v59
    v_cvt_pk_bf16_f32 v120, v56, v60
    v_cvt_pk_bf16_f32 v121, v57, v61
    s_mov_b64 exec, -1
    ds_write2_b32 v11, v118, v119 offset0:0 offset1:32
    ds_write2_b32 v11, v120, v121 offset0:64 offset1:96
    s_mov_b64 exec, 1
    ds_add_u32 v3, v4 offset:12
    s_mov_b64 exec, -1
LwA__1:
    ds_read_b32 v2, v3 offset:12
    s_waitcnt lgkmcnt(0)
    v_cmp_gt_u32 vcc, 8, v2
    s_cbranch_vccnz LwA__1
    ds_read_b32 v118, v42 offset:0
    ds_read_b32 v119, v42 offset:1040
    ds_read_b32 v120, v42 offset:2080
    ds_read_b32 v121, v42 offset:3120
    s_waitcnt lgkmcnt(0)
    v_mfma_f32_16x16x32_bf16 v[122:125], v[118:121], v[34:37], 0
    v_mfma_f32_16x16x32_bf16 v[126:129], v[118:121], v[38:41], 0
    v_xor_b32 v34, 0x80000000, v34
    v_xor_b32 v38, 0x8000, v38
    v_xor_b32 v35, 0x80000000, v35
    v_xor_b32 v39, 0x8000, v39
    v_xor_b32 v36, 0x80000000, v36
    v_xor_b32 v40, 0x8000, v40
    v_xor_b32 v37, 0x80000000, v37
    v_xor_b32 v41, 0x8000, v41
    v_cvt_pk_bf16_f32 v118, v122, v126
    v_cvt_pk_bf16_f32 v119, v123, v127
    v_cvt_pk_bf16_f32 v120, v124, v128
    v_cvt_pk_bf16_f32 v121, v125, v129
    v_and_b32 v118, 0xfffefffe, v118
    s_setprio 3
    global_store_dwordx4 v43, v[118:121], s[22:23] sc1
    s_setprio 0
    s_mov_b64 exec, 1
    ds_add_u32 v3, v4 offset:12
    s_mov_b64 exec, -1
    s_cmp_lg_u32 s24, 0
    s_cbranch_scc1 Lrec_skip
    v_sub_u32 v1, 8, v5
    v_and_b32 v1, 7, v1
    v_lshlrev_b32 v1, 6, v1
    v_add_u32 v1, 162064, v1
    s_mov_b64 exec, 0xff
    ds_write_b32 v1, v118
    s_mov_b64 exec, -1
    s_waitcnt lgkmcnt(0)
Lrec_skip:
    v_mov_b32 v122, 0x3f803f80
    v_mov_b32 v123, 0x3f803f80
    v_mov_b32 v124, 0x3f803f80
    v_mov_b32 v125, 0x3f803f80
    s_barrier
    ds_read_b128 v[152:155], v18 offset:24576
    ds_read_b64_tr_b16 v[128:129], v20 offset:8192
    ds_read_b64_tr_b16 v[130:131], v20 offset:8704
    ds_read_b128 v[156:159], v18 offset:26624
    ds_read_b64_tr_b16 v[132:133], v20 offset:16384
    ds_read_b64_tr_b16 v[134:135], v20 offset:16896
    ds_read_b64_tr_b16 v[136:137], v20 offset:0
    ds_read_b64_tr_b16 v[138:139], v20 offset:512
    s_waitcnt lgkmcnt(0)
    ds_read_b128 v[160:163], v19 offset:24576
    ds_read_b64_tr_b16 v[140:141], v20 offset:12288
    v_mfma_f32_16x16x32_bf16 v[62:65], v[152:155], v[128:131], 0
    ds_read_b64_tr_b16 v[142:143], v20 offset:12800
    ds_read_b128 v[164:167], v19 offset:26624
    v_mfma_f32_16x16x32_bf16 v[66:69], v[156:159], v[128:131], 0
    ds_read_b64_tr_b16 v[144:145], v20 offset:20480
    ds_read_b64_tr_b16 v[146:147], v20 offset:20992
    v_mfma_f32_16x16x32_bf16 v[70:73], v[152:155], v[132:135], 0
    ds_read_b64_tr_b16 v[148:149], v20 offset:4096
    ds_read_b64_tr_b16 v[150:151], v20 offset:4608
    v_mfma_f32_16x16x32_bf16 v[74:77], v[156:159], v[132:135], 0
    v_mfma_f32_16x16x32_bf16 v[78:81], v[136:139], v[152:155], 0
    v_mfma_f32_16x16x32_bf16 v[82:85], v[136:139], v[156:159], 0
    s_barrier
    s_waitcnt lgkmcnt(0)
    ds_read_b128 v[152:155], v18 offset:57344
    ds_read_b64_tr_b16 v[128:129], v20 offset:40960
    v_mfma_f32_16x16x32_bf16 v[62:65], v[160:163], v[140:143], v[62:65]
    ds_read_b64_tr_b16 v[130:131], v20 offset:41472
    ds_read_b128 v[156:159], v18 offset:59392
    v_mfma_f32_16x16x32_bf16 v[66:69], v[164:167], v[140:143], v[66:69]
    ds_read_b64_tr_b16 v[132:133], v20 offset:49152
    ds_read_b64_tr_b16 v[134:135], v20 offset:49664
    v_mfma_f32_16x16x32_bf16 v[70:73], v[160:163], v[144:147], v[70:73]
    ds_read_b64_tr_b16 v[136:137], v20 offset:32768
    ds_read_b64_tr_b16 v[138:139], v20 offset:33280
    v_mfma_f32_16x16x32_bf16 v[74:77], v[164:167], v[144:147], v[74:77]
    v_mfma_f32_16x16x32_bf16 v[78:81], v[148:151], v[160:163], v[78:81]
    v_mfma_f32_16x16x32_bf16 v[82:85], v[148:151], v[164:167], v[82:85]
    s_waitcnt lgkmcnt(0)
    ds_read_b128 v[160:163], v19 offset:57344
    ds_read_b64_tr_b16 v[140:141], v20 offset:45056
    v_mfma_f32_16x16x32_bf16 v[62:65], v[152:155], v[128:131], v[62:65]
    ds_read_b64_tr_b16 v[142:143], v20 offset:45568
    ds_read_b128 v[164:167], v19 offset:59392
    v_mfma_f32_16x16x32_bf16 v[66:69], v[156:159], v[128:131], v[66:69]
    ds_read_b64_tr_b16 v[144:145], v20 offset:53248
    ds_read_b64_tr_b16 v[146:147], v20 offset:53760
    v_mfma_f32_16x16x32_bf16 v[70:73], v[152:155], v[132:135], v[70:73]
    ds_read_b64_tr_b16 v[148:149], v20 offset:36864
    ds_read_b64_tr_b16 v[150:151], v20 offset:37376
    v_mfma_f32_16x16x32_bf16 v[74:77], v[156:159], v[132:135], v[74:77]
    v_mfma_f32_16x16x32_bf16 v[78:81], v[136:139], v[152:155], v[78:81]
    v_mfma_f32_16x16x32_bf16 v[82:85], v[136:139], v[156:159], v[82:85]
    s_waitcnt vmcnt(0)
    s_barrier
    s_waitcnt lgkmcnt(0)
    ds_read_b128 v[152:155], v21 offset:24576
    ds_read_b64_tr_b16 v[128:129], v23 offset:8192
    v_mfma_f32_16x16x32_bf16 v[62:65], v[160:163], v[140:143], v[62:65]
    ds_read_b64_tr_b16 v[130:131], v23 offset:8704
    ds_read_b128 v[156:159], v21 offset:26624
    v_mfma_f32_16x16x32_bf16 v[66:69], v[164:167], v[140:143], v[66:69]
    ds_read_b64_tr_b16 v[132:133], v23 offset:16384
    ds_read_b64_tr_b16 v[134:135], v23 offset:16896
    v_mfma_f32_16x16x32_bf16 v[70:73], v[160:163], v[144:147], v[70:73]
    ds_read_b64_tr_b16 v[136:137], v23 offset:0
    ds_read_b64_tr_b16 v[138:139], v23 offset:512
    v_mfma_f32_16x16x32_bf16 v[74:77], v[164:167], v[144:147], v[74:77]
    v_mfma_f32_16x16x32_bf16 v[78:81], v[148:151], v[160:163], v[78:81]
    v_mfma_f32_16x16x32_bf16 v[82:85], v[148:151], v[164:167], v[82:85]
    s_waitcnt lgkmcnt(0)
    ds_read_b128 v[160:163], v22 offset:24576
    ds_read_b64_tr_b16 v[140:141], v23 offset:12288
    v_mfma_f32_16x16x32_bf16 v[62:65], v[152:155], v[128:131], v[62:65]
    ds_read_b64_tr_b16 v[142:143], v23 offset:12800
    ds_read_b128 v[164:167], v22 offset:26624
    v_mfma_f32_16x16x32_bf16 v[66:69], v[156:159], v[128:131], v[66:69]
    ds_read_b64_tr_b16 v[144:145], v23 offset:20480
    ds_read_b64_tr_b16 v[146:147], v23 offset:20992
    v_mfma_f32_16x16x32_bf16 v[70:73], v[152:155], v[132:135], v[70:73]
    ds_read_b64_tr_b16 v[148:149], v23 offset:4096
    ds_read_b64_tr_b16 v[150:151], v23 offset:4608
    v_mfma_f32_16x16x32_bf16 v[74:77], v[156:159], v[132:135], v[74:77]
    v_mfma_f32_16x16x32_bf16 v[78:81], v[136:139], v[152:155], v[78:81]
    v_mfma_f32_16x16x32_bf16 v[82:85], v[136:139], v[156:159], v[82:85]
    s_barrier
    s_waitcnt lgkmcnt(0)
    ds_read_b128 v[152:155], v21 offset:57344
    ds_read_b64_tr_b16 v[128:129], v23 offset:40960
    v_mfma_f32_16x16x32_bf16 v[62:65], v[160:163], v[140:143], v[62:65]
    ds_read_b64_tr_b16 v[130:131], v23 offset:41472
    ds_read_b128 v[156:159], v21 offset:59392
    v_mfma_f32_16x16x32_bf16 v[66:69], v[164:167], v[140:143], v[66:69]
    ds_read_b64_tr_b16 v[132:133], v23 offset:49152
    ds_read_b64_tr_b16 v[134:135], v23 offset:49664
    v_mfma_f32_16x16x32_bf16 v[70:73], v[160:163], v[144:147], v[70:73]
    ds_read_b64_tr_b16 v[136:137], v23 offset:32768
    ds_read_b64_tr_b16 v[138:139], v23 offset:33280
    v_mfma_f32_16x16x32_bf16 v[74:77], v[164:167], v[144:147], v[74:77]
    v_mfma_f32_16x16x32_bf16 v[78:81], v[148:151], v[160:163], v[78:81]
    v_mfma_f32_16x16x32_bf16 v[82:85], v[148:151], v[164:167], v[82:85]
    s_waitcnt lgkmcnt(0)
    ds_read_b128 v[160:163], v22 offset:57344
    ds_read_b64_tr_b16 v[140:141], v23 offset:45056
    v_mfma_f32_16x16x32_bf16 v[62:65], v[152:155], v[128:131], v[62:65]
    ds_read_b64_tr_b16 v[142:143], v23 offset:45568
    ds_read_b128 v[164:167], v22 offset:59392
    v_mfma_f32_16x16x32_bf16 v[66:69], v[156:159], v[128:131], v[66:69]
    ds_read_b64_tr_b16 v[144:145], v23 offset:53248
    ds_read_b64_tr_b16 v[146:147], v23 offset:53760
    v_mfma_f32_16x16x32_bf16 v[70:73], v[152:155], v[132:135], v[70:73]
    ds_read_b64_tr_b16 v[148:149], v23 offset:36864
    ds_read_b64_tr_b16 v[150:151], v23 offset:37376
    v_mfma_f32_16x16x32_bf16 v[74:77], v[156:159], v[132:135], v[74:77]
    v_mfma_f32_16x16x32_bf16 v[78:81], v[136:139], v[152:155], v[78:81]
    v_mfma_f32_16x16x32_bf16 v[82:85], v[136:139], v[156:159], v[82:85]
    s_barrier
    s_waitcnt lgkmcnt(0)
    ds_read_b128 v[152:155], v18 offset:24576
    ds_read_b64_tr_b16 v[128:129], v20 offset:8192
    v_mfma_f32_16x16x32_bf16 v[62:65], v[160:163], v[140:143], v[62:65]
    ds_read_b64_tr_b16 v[130:131], v20 offset:8704
    ds_read_b128 v[156:159], v18 offset:26624
    v_mfma_f32_16x16x32_bf16 v[66:69], v[164:167], v[140:143], v[66:69]
    ds_read_b64_tr_b16 v[132:133], v20 offset:16384
    ds_read_b64_tr_b16 v[134:135], v20 offset:16896
    v_mfma_f32_16x16x32_bf16 v[70:73], v[160:163], v[144:147], v[70:73]
    ds_read_b64_tr_b16 v[136:137], v20 offset:0
    ds_read_b64_tr_b16 v[138:139], v20 offset:512
    v_mfma_f32_16x16x32_bf16 v[74:77], v[164:167], v[144:147], v[74:77]
    v_mfma_f32_16x16x32_bf16 v[78:81], v[148:151], v[160:163], v[78:81]
    v_mfma_f32_16x16x32_bf16 v[82:85], v[148:151], v[164:167], v[82:85]
    s_waitcnt lgkmcnt(0)
    ds_read_b128 v[160:163], v19 offset:24576
    ds_read_b64_tr_b16 v[140:141], v20 offset:12288
    v_mfma_f32_16x16x32_bf16 v[62:65], v[152:155], v[128:131], v[62:65]
    ds_read_b64_tr_b16 v[142:143], v20 offset:12800
    ds_read_b128 v[164:167], v19 offset:26624
    v_mfma_f32_16x16x32_bf16 v[66:69], v[156:159], v[128:131], v[66:69]
    ds_read_b64_tr_b16 v[144:145], v20 offset:20480
    ds_read_b64_tr_b16 v[146:147], v20 offset:20992
    v_mfma_f32_16x16x32_bf16 v[70:73], v[152:155], v[132:135], v[70:73]
    ds_read_b64_tr_b16 v[148:149], v20 offset:4096
    ds_read_b64_tr_b16 v[150:151], v20 offset:4608
    v_mfma_f32_16x16x32_bf16 v[74:77], v[156:159], v[132:135], v[74:77]
    v_mfma_f32_16x16x32_bf16 v[78:81], v[136:139], v[152:155], v[78:81]
    v_mfma_f32_16x16x32_bf16 v[82:85], v[136:139], v[156:159], v[82:85]
    s_barrier
    s_waitcnt lgkmcnt(0)
    ds_read_b128 v[152:155], v18 offset:57344
    ds_read_b64_tr_b16 v[128:129], v20 offset:40960
    v_mfma_f32_16x16x32_bf16 v[62:65], v[160:163], v[140:143], v[62:65]
    ds_read_b64_tr_b16 v[130:131], v20 offset:41472
    ds_read_b128 v[156:159], v18 offset:59392
    v_mfma_f32_16x16x32_bf16 v[66:69], v[164:167], v[140:143], v[66:69]
    ds_read_b64_tr_b16 v[132:133], v20 offset:49152
    ds_read_b64_tr_b16 v[134:135], v20 offset:49664
    v_mfma_f32_16x16x32_bf16 v[70:73], v[160:163], v[144:147], v[70:73]
    ds_read_b64_tr_b16 v[136:137], v20 offset:32768
    ds_read_b64_tr_b16 v[138:139], v20 offset:33280
    v_mfma_f32_16x16x32_bf16 v[74:77], v[164:167], v[144:147], v[74:77]
    v_mfma_f32_16x16x32_bf16 v[78:81], v[148:151], v[160:163], v[78:81]
    v_mfma_f32_16x16x32_bf16 v[82:85], v[148:151], v[164:167], v[82:85]
    s_waitcnt lgkmcnt(0)
    ds_read_b128 v[160:163], v19 offset:57344
    ds_read_b64_tr_b16 v[140:141], v20 offset:45056
    v_mfma_f32_16x16x32_bf16 v[62:65], v[152:155], v[128:131], v[62:65]
    ds_read_b64_tr_b16 v[142:143], v20 offset:45568
    ds_read_b128 v[164:167], v19 offset:59392
    v_mfma_f32_16x16x32_bf16 v[66:69], v[156:159], v[128:131], v[66:69]
    ds_read_b64_tr_b16 v[144:145], v20 offset:53248
    ds_read_b64_tr_b16 v[146:147], v20 offset:53760
    v_mfma_f32_16x16x32_bf16 v[70:73], v[152:155], v[132:135], v[70:73]
    ds_read_b64_tr_b16 v[148:149], v20 offset:36864
    ds_read_b64_tr_b16 v[150:151], v20 offset:37376
    v_mfma_f32_16x16x32_bf16 v[74:77], v[156:159], v[132:135], v[74:77]
    v_mfma_f32_16x16x32_bf16 v[78:81], v[136:139], v[152:155], v[78:81]
    v_mfma_f32_16x16x32_bf16 v[82:85], v[136:139], v[156:159], v[82:85]
    s_barrier
    s_waitcnt lgkmcnt(0)
    ds_read_b128 v[152:155], v21 offset:24576
    ds_read_b64_tr_b16 v[128:129], v23 offset:8192
    v_mfma_f32_16x16x32_bf16 v[62:65], v[160:163], v[140:143], v[62:65]
    ds_read_b64_tr_b16 v[130:131], v23 offset:8704
    ds_read_b128 v[156:159], v21 offset:26624
    v_mfma_f32_16x16x32_bf16 v[66:69], v[164:167], v[140:143], v[66:69]
    ds_read_b64_tr_b16 v[132:133], v23 offset:16384
    ds_read_b64_tr_b16 v[134:135], v23 offset:16896
    v_mfma_f32_16x16x32_bf16 v[70:73], v[160:163], v[144:147], v[70:73]
    ds_read_b64_tr_b16 v[136:137], v23 offset:0
    ds_read_b64_tr_b16 v[138:139], v23 offset:512
    v_mfma_f32_16x16x32_bf16 v[74:77], v[164:167], v[144:147], v[74:77]
    v_mfma_f32_16x16x32_bf16 v[78:81], v[148:151], v[160:163], v[78:81]
    v_mfma_f32_16x16x32_bf16 v[82:85], v[148:151], v[164:167], v[82:85]
    s_waitcnt lgkmcnt(0)
    ds_read_b128 v[160:163], v22 offset:24576
    ds_read_b64_tr_b16 v[140:141], v23 offset:12288
    v_mfma_f32_16x16x32_bf16 v[62:65], v[152:155], v[128:131], v[62:65]
    ds_read_b64_tr_b16 v[142:143], v23 offset:12800
    ds_read_b128 v[164:167], v22 offset:26624
    v_mfma_f32_16x16x32_bf16 v[66:69], v[156:159], v[128:131], v[66:69]
    ds_read_b64_tr_b16 v[144:145], v23 offset:20480
    ds_read_b64_tr_b16 v[146:147], v23 offset:20992
    v_mfma_f32_16x16x32_bf16 v[70:73], v[152:155], v[132:135], v[70:73]
    ds_read_b64_tr_b16 v[148:149], v23 offset:4096
    ds_read_b64_tr_b16 v[150:151], v23 offset:4608
    v_mfma_f32_16x16x32_bf16 v[74:77], v[156:159], v[132:135], v[74:77]
    v_mfma_f32_16x16x32_bf16 v[78:81], v[136:139], v[152:155], v[78:81]
    v_mfma_f32_16x16x32_bf16 v[82:85], v[136:139], v[156:159], v[82:85]
    s_barrier
    s_waitcnt lgkmcnt(0)
    ds_read_b128 v[152:155], v21 offset:57344
    ds_read_b64_tr_b16 v[128:129], v23 offset:40960
    v_mfma_f32_16x16x32_bf16 v[62:65], v[160:163], v[140:143], v[62:65]
    ds_read_b64_tr_b16 v[130:131], v23 offset:41472
    ds_read_b128 v[156:159], v21 offset:59392
    v_mfma_f32_16x16x32_bf16 v[66:69], v[164:167], v[140:143], v[66:69]
    ds_read_b64_tr_b16 v[132:133], v23 offset:49152
    ds_read_b64_tr_b16 v[134:135], v23 offset:49664
    v_mfma_f32_16x16x32_bf16 v[70:73], v[160:163], v[144:147], v[70:73]
    ds_read_b64_tr_b16 v[136:137], v23 offset:32768
    ds_read_b64_tr_b16 v[138:139], v23 offset:33280
    v_mfma_f32_16x16x32_bf16 v[74:77], v[164:167], v[144:147], v[74:77]
    v_mfma_f32_16x16x32_bf16 v[78:81], v[148:151], v[160:163], v[78:81]
    v_mfma_f32_16x16x32_bf16 v[82:85], v[148:151], v[164:167], v[82:85]
    ds_read_b128 v[160:163], v22 offset:57344
    ds_read_b64_tr_b16 v[140:141], v23 offset:45056
    ds_read_b64_tr_b16 v[142:143], v23 offset:45568
    ds_read_b128 v[164:167], v22 offset:59392
    ds_read_b64_tr_b16 v[144:145], v23 offset:53248
    ds_read_b64_tr_b16 v[146:147], v23 offset:53760
    ds_read_b64_tr_b16 v[148:149], v23 offset:36864
    ds_read_b64_tr_b16 v[150:151], v23 offset:37376
    s_setprio 2
    s_waitcnt lgkmcnt(10)
    v_mfma_f32_16x16x32_bf16 v[62:65], v[152:155], v[128:131], v[62:65]
    v_mfma_f32_16x16x32_bf16 v[66:69], v[156:159], v[128:131], v[66:69]
    v_mfma_f32_16x16x32_bf16 v[70:73], v[152:155], v[132:135], v[70:73]
    v_mfma_f32_16x16x32_bf16 v[74:77], v[156:159], v[132:135], v[74:77]
    s_waitcnt lgkmcnt(4)
    v_mfma_f32_16x16x32_bf16 v[62:65], v[160:163], v[140:143], v[62:65]
    v_mfma_f32_16x16x32_bf16 v[66:69], v[164:167], v[140:143], v[66:69]
    s_waitcnt lgkmcnt(2)
    v_mfma_f32_16x16x32_bf16 v[70:73], v[160:163], v[144:147], v[70:73]
    v_mfma_f32_16x16x32_bf16 v[74:77], v[164:167], v[144:147], v[74:77]
    s_waitcnt lgkmcnt(0)
    s_nop 2
    v_pk_mul_f32 v[54:55], v[62:63], s[40:41]
    v_pk_mul_f32 v[56:57], v[64:65], s[40:41]
    v_pk_mul_f32 v[58:59], v[66:67], s[40:41]
    v_pk_mul_f32 v[60:61], v[68:69], s[40:41]
    v_exp_f32_e64 v54, v54 clamp
    v_max_f32 v62, 0, v62
    v_exp_f32_e64 v55, v55 clamp
    v_max_f32 v63, 0, v63
    v_exp_f32_e64 v56, v56 clamp
    v_max_f32 v64, 0, v64
    v_exp_f32_e64 v57, v57 clamp
    v_max_f32 v65, 0, v65
    v_exp_f32_e64 v58, v58 clamp
    v_max_f32 v66, 0, v66
    v_exp_f32_e64 v59, v59 clamp
    v_max_f32 v67, 0, v67
    v_exp_f32_e64 v60, v60 clamp
    v_max_f32 v68, 0, v68
    v_exp_f32_e64 v61, v61 clamp
    v_max_f32 v69, 0, v69
    v_pk_add_f32 v[62:63], v[62:63], s[42:43]
    v_pk_add_f32 v[64:65], v[64:65], s[42:43]
    v_pk_add_f32 v[66:67], v[66:67], s[42:43]
    v_pk_add_f32 v[68:69], v[68:69], s[42:43]
    v_pk_add_f32 v[62:63], v[62:63], v[54:55]
    v_pk_add_f32 v[64:65], v[64:65], v[56:57]
    v_pk_add_f32 v[66:67], v[66:67], v[58:59]
    v_pk_add_f32 v[68:69], v[68:69], v[60:61]
    v_cvt_pk_bf16_f32 v132, v70, v71
    v_cvt_pk_bf16_f32 v133, v72, v73
    v_cvt_pk_bf16_f32 v134, v74, v75
    v_cvt_pk_bf16_f32 v135, v76, v77
    v_cvt_pk_bf16_f32 v128, v62, v63
    v_cvt_pk_bf16_f32 v129, v64, v65
    v_cvt_pk_bf16_f32 v130, v66, v67
    v_cvt_pk_bf16_f32 v131, v68, v69
    s_nop 1
    v_mfma_f32_16x16x32_bf16 v[62:65], v[128:131], v[132:135], 0
    v_mfma_f32_16x16x32_bf16 v[66:69], v[128:131], v[122:125], 0
    v_mfma_f32_16x16x32_bf16 v[78:81], v[136:139], v[152:155], v[78:81]
    v_mfma_f32_16x16x32_bf16 v[82:85], v[136:139], v[156:159], v[82:85]
    v_mfma_f32_16x16x32_bf16 v[78:81], v[148:151], v[160:163], v[78:81]
    v_mfma_f32_16x16x32_bf16 v[82:85], v[148:151], v[164:167], v[82:85]
    s_nop 2
    ds_write_b128 v16, v[62:65]
    s_mov_b32 exec_lo, 0x00010001
    s_mov_b32 exec_hi, 0x00010001
    ds_write_b128 v17, v[66:69]
    s_mov_b64 exec, 1
    ds_add_u32 v3, v4 offset:40
    s_mov_b64 exec, -1
    s_setprio 0
    v_pk_mul_f32 v[54:55], v[78:79], s[40:41]
    v_pk_mul_f32 v[56:57], v[80:81], s[40:41]
    v_pk_mul_f32 v[58:59], v[82:83], s[40:41]
    v_pk_mul_f32 v[60:61], v[84:85], s[40:41]
    v_exp_f32_e64 v54, v54 clamp
    v_max_f32 v78, 0, v78
    v_exp_f32_e64 v55, v55 clamp
    v_max_f32 v79, 0, v79
    v_exp_f32_e64 v56, v56 clamp
    v_max_f32 v80, 0, v80
    v_exp_f32_e64 v57, v57 clamp
    v_max_f32 v81, 0, v81
    v_exp_f32_e64 v58, v58 clamp
    v_max_f32 v82, 0, v82
    v_exp_f32_e64 v59, v59 clamp
    v_max_f32 v83, 0, v83
    v_exp_f32_e64 v60, v60 clamp
    v_max_f32 v84, 0, v84
    v_exp_f32_e64 v61, v61 clamp
    v_max_f32 v85, 0, v85
    v_pk_add_f32 v[78:79], v[78:79], s[42:43]
    v_pk_add_f32 v[80:81], v[80:81], s[42:43]
    v_pk_add_f32 v[82:83], v[82:83], s[42:43]
    v_pk_add_f32 v[84:85], v[84:85], s[42:43]
    v_pk_add_f32 v[78:79], v[78:79], v[54:55]
    v_pk_add_f32 v[80:81], v[80:81], v[56:57]
    v_pk_add_f32 v[82:83], v[82:83], v[58:59]
    v_pk_add_f32 v[84:85], v[84:85], v[60:61]
    v_cvt_pk_bf16_f32 v140, v78, v79
    v_cvt_pk_bf16_f32 v141, v80, v81
    v_cvt_pk_bf16_f32 v142, v82, v83
    v_cvt_pk_bf16_f32 v143, v84, v85
    s_nop 0
    v_permlane16_swap_b32 v140, v142
    v_permlane16_swap_b32 v141, v143
    s_setprio 3
    global_store_dwordx4 v15, v[140:143], s[22:23] sc1
    s_setprio 0
    s_mov_b64 exec, 1
    ds_add_u32 v3, v4 offset:16
    s_mov_b64 exec, -1
    v_mov_b32 v58, 0
    v_mov_b32 v62, 0
    v_mov_b32 v59, 0
    v_mov_b32 v63, 0
    v_mov_b32 v60, 0
    v_mov_b32 v64, 0
    v_mov_b32 v61, 0
    v_mov_b32 v65, 0
    s_branch LwB1__2f
LwB1__2:
    s_sleep 1
LwB1__2f:
    ds_read_b32 v2, v3 offset:28
    s_waitcnt lgkmcnt(0)
    v_cmp_gt_u32 vcc, 3, v2
    s_cbranch_vccnz LwB1__2
    ds_read2st64_b32 v[20:21], v12 offset0:0 offset1:2
    ds_read2st64_b32 v[22:23], v12 offset0:4 offset1:6
    s_cmp_eq_u32 s36, 0
    s_waitcnt lgkmcnt(0)
    v_mfma_f32_16x16x32_bf16 v[42:45], v[20:23], v[46:49], 0
    v_mfma_f32_16x16x32_bf16 v[54:57], v[20:23], v[50:53], 0
    s_cbranch_scc1 Lsp_rd
    ds_read_u16_d16_hi v58, v13 offset:0
    ds_read_u16_d16_hi v59, v13 offset:256
    ds_read_u16_d16_hi v60, v13 offset:512
    ds_read_u16_d16_hi v61, v13 offset:768
    ds_read_u16_d16_hi v62, v13 offset:4096
    ds_read_u16_d16_hi v63, v13 offset:4352
    ds_read_u16_d16_hi v64, v13 offset:4608
    ds_read_u16_d16_hi v65, v13 offset:4864
Lsp_now:
    v_pk_mul_f32 v[164:165], v[42:43], v[86:87]
    v_pk_mul_f32 v[166:167], v[44:45], v[88:89]
    v_pk_mul_f32 v[160:161], v[42:43], v[90:91] neg_lo:[1,0] neg_hi:[1,0]
    v_pk_mul_f32 v[162:163], v[44:45], v[92:93] neg_lo:[1,0] neg_hi:[1,0]
    v_pk_fma_f32 v[164:165], v[54:55], v[90:91], v[164:165]
    v_pk_fma_f32 v[160:161], v[54:55], v[86:87], v[160:161]
    v_pk_fma_f32 v[166:167], v[56:57], v[92:93], v[166:167]
    v_pk_fma_f32 v[162:163], v[56:57], v[88:89], v[162:163]
    v_cvt_pk_bf16_f32 v20, v164, v160
    v_cvt_pk_bf16_f32 v21, v165, v161
    v_cvt_pk_bf16_f32 v22, v166, v162
    v_cvt_pk_bf16_f32 v23, v167, v163
    s_nop 1
    v_mfma_f32_16x16x32_bf16 v[42:45], v[94:97], v[20:23], 0
    v_mfma_f32_16x16x32_bf16 v[54:57], v[98:101], v[20:23], 0
    v_xor_b32 v94, 0x80000000, v94
    v_xor_b32 v98, 0x8000, v98
    v_xor_b32 v95, 0x80000000, v95
    v_xor_b32 v99, 0x8000, v99
    v_xor_b32 v96, 0x80000000, v96
    v_xor_b32 v100, 0x8000, v100
    v_xor_b32 v97, 0x80000000, v97
    v_xor_b32 v101, 0x8000, v101
    s_waitcnt lgkmcnt(0)
    s_cbranch_scc1 Lsp
    v_pk_mul_f32 v[164:165], v[42:43], v[58:59]
    v_pk_mul_f32 v[166:167], v[44:45], v[60:61]
    v_pk_mul_f32 v[160:161], v[42:43], v[62:63]
    v_pk_mul_f32 v[162:163], v[44:45], v[64:65]
    v_pk_fma_f32 v[164:165], v[54:55], v[62:63], v[164:165] neg_lo:[1,0,0] neg_hi:[1,0,0]
    v_pk_fma_f32 v[160:161], v[54:55], v[58:59], v[160:161]
    v_pk_fma_f32 v[166:167], v[56:57], v[64:65], v[166:167] neg_lo:[1,0,0] neg_hi:[1,0,0]
    v_pk_fma_f32 v[162:163], v[56:57], v[60:61], v[162:163]
    v_cvt_pk_bf16_f32 v20, v164, v160
    v_cvt_pk_bf16_f32 v21, v165, v161
    v_cvt_pk_bf16_f32 v22, v166, v162
    v_cvt_pk_bf16_f32 v23, v167, v163
Lspj:
    s_nop 1
    v_mfma_f32_16x16x32_bf16 v[42:45], v[20:23], v[94:97], 0
    v_mfma_f32_16x16x32_bf16 v[54:57], v[20:23], v[98:101], 0
    s_nop 6
    v_pk_mul_f32 v[164:165], v[42:43], v[102:103]
    v_pk_mul_f32 v[166:167], v[44:45], v[104:105]
    v_pk_mul_f32 v[160:161], v[42:43], v[106:107]
    v_pk_mul_f32 v[162:163], v[44:45], v[108:109]
    v_pk_fma_f32 v[164:165], v[54:55], v[106:107], v[164:165] neg_lo:[1,0,0] neg_hi:[1,0,0]
    v_pk_fma_f32 v[160:161], v[54:55], v[102:103], v[160:161]
    v_pk_fma_f32 v[166:167], v[56:57], v[108:109], v[166:167] neg_lo:[1,0,0] neg_hi:[1,0,0]
    v_pk_fma_f32 v[162:163], v[56:57], v[104:105], v[162:163]
    v_cvt_pk_bf16_f32 v20, v164, v160
    v_cvt_pk_bf16_f32 v21, v165, v161
    v_cvt_pk_bf16_f32 v22, v166, v162
    v_cvt_pk_bf16_f32 v23, v167, v163
    s_nop 1
    v_mfma_f32_16x16x32_bf16 v[42:45], v[110:113], v[20:23], 0
    v_mfma_f32_16x16x32_bf16 v[54:57], v[114:117], v[20:23], 0
    s_mov_b32 s30, 0xfffefffe
    s_nop 6
    v_cvt_pk_bf16_f32 v20, v42, v54
    v_cvt_pk_bf16_f32 v21, v43, v55
    v_cvt_pk_bf16_f32 v22, v44, v56
    v_cvt_pk_bf16_f32 v23, v45, v57
    ds_write2st64_b32 v12, v20, v21 offset0:0 offset1:2
    ds_write2st64_b32 v12, v22, v23 offset0:4 offset1:6
    s_mov_b64 exec, 1
    ds_add_u32 v3, v4 offset:32
    s_mov_b64 exec, -1
    s_waitcnt vmcnt(0)
    s_mov_b64 exec, 1
    ds_add_u32 v3, v4 offset:20
    s_mov_b64 exec, -1
LwB2:
    ds_read_b32 v2, v3 offset:32
    ds_read_b128 v[20:23], v10
    s_waitcnt lgkmcnt(0)
    v_cmp_gt_u32 vcc, 9, v2
    s_cbranch_vccnz LwB2
    s_setprio 3
    v_and_or_b32 v20, v20, s30, 1
    global_store_dwordx4 v14, v[20:23], s[22:23] sc1
    s_setprio 0
    s_mov_b64 exec, 1
    ds_add_u32 v3, v4 offset:36
    s_mov_b64 exec, -1
    v_and_b32 v47, 31, v5
    v_lshrrev_b32 v48, 5, v5
    v_and_b32 v2, 7, v5
    v_bfe_u32 v1, v5, 3, 2
    v_lshl_add_u32 v9, v2, 4, v1
    s_lshl_b32 s30, s25, 5
    s_add_u32 s30, s30, s35
    s_lshl_b32 s30, s30, 4
    s_add_u32 s30, s30, 8454144
    v_lshl_add_u32 v9, v9, 2, s30
    global_load_dword v9, v9, s[22:23] sc1
    v_mul_u32_u24 v17, 264192, v1
    v_lshl_add_u32 v17, v2, 6, v17
    v_lshl_add_u32 v17, v48, 4, v17
    s_lshl_b32 s30, s35, 5
    s_add_u32 s30, s30, s26
    s_lshl_b32 s30, s30, 1
    s_lshr_b32 s31, s34, 1
    s_add_u32 s30, s30, s31
    s_mul_i32 s30, s30, 16512
    s_lshl_b32 s31, s25, 9
    s_add_u32 s30, s30, s31
    s_and_b32 s31, s34, 1
    s_lshl_b32 s31, s31, 5
    s_add_u32 s30, s30, s31
    v_add_u32 v17, s30, v17
    v_lshl_add_u32 v16, v1, 8, v2
    v_lshlrev_b32 v16, 10, v16
    v_lshl_add_u32 v16, v48, 4, v16
    s_lshl_b32 s30, s35, 7
    s_add_u32 s30, s30, s25
    s_lshl_b32 s30, s30, 6
    s_add_u32 s30, s30, s26
    s_lshl_b32 s30, s30, 2
    s_add_u32 s30, s30, s34
    s_lshl_b32 s30, s30, 5
    v_add_u32 v16, s30, v16
    s_lshl_b32 s30, s24, 2
    s_add_u32 s30, s30, 162560
    v_mov_b32 v25, s30
    ds_read_b32 v25, v25
    s_mov_b64 exec, 0xffff
    v_mov_b32 v94, 0x3f803f80
    s_mov_b64 exec, -1
    v_xor_b32 v1, v48, v7
    v_and_b32 v1, 1, v1
    v_lshl_add_u32 v1, v1, 4, v6
    v_and_b32 v2, 1, v7
    v_lshl_add_u32 v1, v2, 7, v1
    s_add_u32 s30, s33, 131072
    v_lshl_add_u32 v19, v1, 2, s30
    v_lshrrev_b32 v1, 3, v6
    v_lshl_add_u32 v1, v1, 2, v7
    v_xor_b32 v1, v1, v6
    v_and_b32 v1, 7, v1
    v_and_b32 v24, 7, v6
    v_lshl_add_u32 v24, v24, 3, v1
    v_lshl_add_u32 v24, v24, 4, s30
    s_mul_i32 s31, s24, 1040
    s_add_u32 s31, s31, 139392
    v_subrev_u32 v11, s31, v11
    v_and_b32 v1, 127, v11
    s_lshl_b32 s31, s24, 4
    v_xor_b32 v1, s31, v1
    v_lshrrev_b32 v11, 7, v11
    v_lshl_add_u32 v11, v11, 10, v1
    s_lshl_b32 s31, s24, 7
    s_add_u32 s31, s31, 131072
    v_add_u32 v11, s31, v11
    v_mul_u32_u24 v46, 16512, v6
    v_lshl_add_u32 v46, v2, 5, v46
    v_lshl_add_u32 v46, v48, 4, v46
    s_mul_i32 s31, s24, 264192
    s_lshl_b32 s30, s27, 6
    s_add_u32 s31, s31, s30
    v_add_u32 v46, s31, v46
    s_lshl_b32 s30, s24, 13
    s_add_u32 s30, s30, 65536
    v_add_u32 v10, s30, v8
    v_lshl_add_u32 v12, v6, 1, v48
    s_lshl_b32 s30, s34, 8
    v_add_u32 v12, s30, v12
    s_lshl_b32 s30, s34, 4
    s_add_u32 s30, s30, 1024
    v_add_u32 v1, s30, v48
    v_cmp_gt_u32 vcc, 16, v47
    s_nop 1
    v_cndmask_b32 v12, v1, v12, vcc
    v_bfe_u32 v1, v12, 4, 1
    v_xor_b32 v12, v12, v1
    v_lshlrev_b32 v12, 4, v12
    v_add_u32 v12, 139392, v12
    v_mov_b32 v13, 512
    v_cndmask_b32 v13, 32, v13, vcc
    v_lshrrev_b32 v1, 2, v6
    v_lshl_add_u32 v1, v2, 2, v1
    v_lshl_add_u32 v1, v48, 4, v1
    v_lshlrev_b32 v1, 7, v1
    v_lshrrev_b32 v14, 3, v6
    v_lshl_or_b32 v14, v2, 1, v14
    v_xor_b32 v14, s34, v14
    v_lshl_add_u32 v1, v14, 5, v1
    v_and_b32 v14, 3, v6
    v_lshl_add_u32 v14, v14, 3, v1
    v_lshl_add_u32 v1, v2, 5, v6
    v_lshl_add_u32 v1, v48, 6, v1
    s_lshl_b32 s30, s35, 15
    s_add_u32 s30, s30, 65536
    v_lshl_add_u32 v15, v1, 4, s30
    v_lshrrev_b32 v1, 3, v5
    v_xor_b32 v18, v1, v5
    v_bfe_u32 v18, v18, 2, 1
    v_lshl_add_u32 v1, v1, 4, v18
    v_mul_u32_u24 v18, 16512, v1
    v_and_b32 v1, 1, v5
    v_lshl_add_u32 v18, v1, 4, v18
    v_and_b32 v1, 2, v5
    v_lshl_add_u32 v18, v1, 5, v18
    s_lshl_b32 s30, s27, 6
    s_and_b32 s31, s27, 1
    s_lshl_b32 s31, s31, 5
    s_sub_u32 s30, s30, s31
    v_add_u32 v18, s30, v18
    s_mul_i32 s31, s24, 33024
    v_add_u32 v18, s31, v18
    s_branch LwD__3f
LwD__3:
    s_sleep 1
LwD__3f:
    ds_read_b32 v2, v3 offset:56
    s_waitcnt lgkmcnt(0)
    v_cmp_gt_u32 vcc, 1, v2
    s_cbranch_vccnz LwD__3
    v_add_u32 v1, 156928, v8
    ds_read_b128 v[50:53], v1 offset:0
    ds_read_b128 v[58:61], v1 offset:1024
    ds_read_b128 v[62:65], v1 offset:2048
    ds_read_b128 v[66:69], v1 offset:3072
    ds_read_b128 v[70:73], v1 offset:4096
    v_mul_f32 v25, 0x36000000, v25
    v_mul_f32 v26, v26, v25
    v_mul_f32 v30, v30, v25
    v_mul_f32 v27, v27, v25
    v_mul_f32 v31, v31, v25
    v_mul_f32 v28, v28, v25
    v_mul_f32 v32, v32, v25
    v_mul_f32 v29, v29, v25
    v_mul_f32 v33, v33, v25
    s_waitcnt vmcnt(0)
    v_sub_f32 v9, 1.0, v9
    s_mov_b32 s37, 0
Ldy:
    ds_read_b96 v[20:22], v3
    s_waitcnt lgkmcnt(0)
    v_readfirstlane_b32 s30, v21
    v_readfirstlane_b32 s31, v20
    s_cmp_lg_u32 s30, 0
    s_cbranch_scc1 Lx2_first
    s_lshr_b32 s31, s31, 1
    s_andn2_b32 s31, s31, s37
    s_cbranch_scc1 Ldy_k
    v_readfirstlane_b32 s31, v22
    s_nop 0
    s_lshl_b32 s31, s31, 1
    s_andn2_b32 s31, s31, s37
    s_cbranch_scc1 Ldy_v
    s_sleep 1
    s_branch Ldy
Ldy_k:
    s_or_b32 s37, s37, 1
    ds_read_b128 v[164:167], v10 offset:0
    ds_read_b128 v[160:163], v10 offset:1024
    ds_read_b128 v[156:159], v10 offset:2048
    ds_read_b128 v[152:155], v10 offset:3072
    ds_read_b128 v[148:151], v10 offset:4096
    ds_read_b128 v[144:147], v10 offset:5120
    ds_read_b128 v[140:143], v10 offset:6144
    ds_read_b128 v[136:139], v10 offset:7168
    ds_read_b64_tr_b16 v[100:101], v14 offset:0
    ds_read_b64_tr_b16 v[102:103], v14 offset:1024
    ds_read_b64_tr_b16 v[90:91], v14 offset:4096
    ds_read_b64_tr_b16 v[92:93], v14 offset:5120
    ds_read_b64_tr_b16 v[86:87], v14 offset:8192
    ds_read_b64_tr_b16 v[88:89], v14 offset:9216
    ds_read_b64_tr_b16 v[82:83], v14 offset:12288
    ds_read_b64_tr_b16 v[84:85], v14 offset:13312
    s_branch Ldy
Ldy_v:
    s_or_b32 s37, s37, 2
    v_mov_b32 v1, v12
    ds_read_b128 v[132:135], v1
    v_add_u32 v1, v1, v13
    ds_read_b128 v[128:131], v1
    v_add_u32 v1, v1, v13
    ds_read_b128 v[124:127], v1
    v_add_u32 v1, v1, v13
    ds_read_b128 v[120:123], v1
    v_add_u32 v1, v1, v13
    ds_read_b128 v[116:119], v1
    v_add_u32 v1, v1, v13
    ds_read_b128 v[112:115], v1
    v_add_u32 v1, v1, v13
    ds_read_b128 v[108:111], v1
    v_add_u32 v1, v1, v13
    ds_read_b128 v[104:107], v1
    s_branch Ldy
Lx2:
    global_load_lds_dwordx4 v18, s[22:23] sc1
    s_waitcnt vmcnt(0)
Lx2_first:
    ds_read2_b32 v[20:21], v19 offset0:0 offset1:32
    ds_read2_b32 v[22:23], v19 offset0:64 offset1:96
    s_waitcnt lgkmcnt(0)
    v_mfma_f32_16x16x32_bf16 v[42:45], v[20:23], v[34:37], 0
    v_mfma_f32_16x16x32_bf16 v[54:57], v[20:23], v[38:41], 0
    v_and_b32 v1, v20, v21
    v_bitop3_b32 v1, v1, v22, v23 bitop3:0x80
    v_and_b32 v1, 1, v1
    s_mov_b32 exec_lo, 0x11111111
    s_mov_b32 exec_hi, 0x11111111
    v_cmp_eq_u32 vcc, 0, v1
    s_mov_b64 exec, -1
    s_cbranch_vccz Lx2_ok
    s_cmp_eq_u32 s32, 0
    s_cbranch_scc1 Lx2_ok
    s_sub_u32 s32, s32, 1
    s_sleep 4
    s_branch Lx2
Lx2_ok:
    v_cvt_pk_bf16_f32 v20, v42, v54
    v_cvt_pk_bf16_f32 v21, v43, v55
    v_cvt_pk_bf16_f32 v22, v44, v56
    v_cvt_pk_bf16_f32 v23, v45, v57
    ds_write_b128 v24, v[20:23]
    s_mov_b64 exec, 1
    ds_add_u32 v3, v4 offset:48
    s_mov_b64 exec, -1
LwC:
    ds_read_b32 v2, v3 offset:48
    ds_read2st64_b32 v[20:21], v11 offset0:0 offset1:4
    ds_read2st64_b32 v[22:23], v11 offset0:8 offset1:12
    s_waitcnt lgkmcnt(0)
    v_cmp_gt_u32 vcc, 8, v2
    s_cbranch_vccnz LwC
    v_mfma_f32_16x16x32_bf16 v[34:37], v[20:23], v[62:65], 0
    v_mfma_f32_16x16x32_bf16 v[38:41], v[20:23], v[66:69], 0
    v_mfma_f32_16x16x32_bf16 v[42:45], v[20:23], v[50:53], 0
    v_mfma_f32_16x16x32_bf16 v[54:57], v[20:23], v[58:61], 0
    ds_read_b32 v2, v3 offset:52
    s_mov_b64 exec, 0xffff
    s_nop 4
    v_mov_b32 v42, v34
    v_mov_b32 v54, v38
    s_mov_b64 exec, -1
    v_pk_mul_f32 v[78:79], v[42:43], v[26:27]
    v_pk_mul_f32 v[80:81], v[44:45], v[28:29]
    v_pk_mul_f32 v[74:75], v[42:43], v[30:31]
    v_pk_mul_f32 v[76:77], v[44:45], v[32:33]
    v_pk_fma_f32 v[78:79], v[54:55], v[30:31], v[78:79] neg_lo:[1,0,0] neg_hi:[1,0,0]
    v_pk_fma_f32 v[74:75], v[54:55], v[26:27], v[74:75]
    v_pk_fma_f32 v[80:81], v[56:57], v[32:33], v[80:81] neg_lo:[1,0,0] neg_hi:[1,0,0]
    v_pk_fma_f32 v[76:77], v[56:57], v[28:29], v[76:77]
    v_cvt_pk_bf16_f32 v20, v78, v74
    v_cvt_pk_bf16_f32 v21, v79, v75
    v_cvt_pk_bf16_f32 v22, v80, v76
    v_cvt_pk_bf16_f32 v23, v81, v77
    s_nop 1
    v_mfma_f32_16x16x32_bf16 v[42:45], v[20:23], v[94:97], 0
    v_mfma_f32_16x16x32_bf16 v[54:57], v[20:23], v[70:73], 0
    s_waitcnt lgkmcnt(0)
    v_cmp_gt_u32 vcc, 1, v2
    s_nop 4
    v_cvt_pk_bf16_f32 v20, v42, v43
    v_cvt_pk_bf16_f32 v21, v44, v45
    v_cvt_pk_bf16_f32 v22, v54, v55
    v_cvt_pk_bf16_f32 v23, v56, v57
    s_nop 0
    v_permlane16_swap_b32 v20, v22
    v_permlane16_swap_b32 v21, v23
    v_or_b32 v20, 0x10000, v20
    s_cbranch_vccz Lz_ok
LwZ__4:
    ds_read_b32 v2, v3 offset:52
    s_waitcnt lgkmcnt(0)
    v_cmp_gt_u32 vcc, 1, v2
    s_cbranch_vccnz LwZ__4
Lz_ok:
    global_store_dwordx4 v46, v[20:23], s[22:23] sc1
    s_bitcmp1_b32 s37, 0
    s_cbranch_scc1 Lhave_pq
LwK__5:
    ds_read_b32 v2, v3 offset:0
    s_waitcnt lgkmcnt(0)
    v_cmp_gt_u32 vcc, 2, v2
    s_cbranch_vccnz LwK__5
    ds_read_b128 v[164:167], v10 offset:0
    ds_read_b128 v[160:163], v10 offset:1024
    ds_read_b128 v[156:159], v10 offset:2048
    ds_read_b128 v[152:155], v10 offset:3072
    ds_read_b128 v[148:151], v10 offset:4096
    ds_read_b128 v[144:147], v10 offset:5120
    ds_read_b128 v[140:143], v10 offset:6144
    ds_read_b128 v[136:139], v10 offset:7168
    ds_read_b64_tr_b16 v[100:101], v14 offset:0
    ds_read_b64_tr_b16 v[102:103], v14 offset:1024
    ds_read_b64_tr_b16 v[90:91], v14 offset:4096
    ds_read_b64_tr_b16 v[92:93], v14 offset:5120
    ds_read_b64_tr_b16 v[86:87], v14 offset:8192
    ds_read_b64_tr_b16 v[88:89], v14 offset:9216
    ds_read_b64_tr_b16 v[82:83], v14 offset:12288
    ds_read_b64_tr_b16 v[84:85], v14 offset:13312
Lhave_pq:
    s_bitcmp1_b32 s37, 1
    s_cbranch_scc1 Lhave_kv
LwV__6:
    ds_read_b32 v2, v3 offset:8
    s_waitcnt lgkmcnt(0)
    v_cmp_gt_u32 vcc, 1, v2
    s_cbranch_vccnz LwV__6
    v_mov_b32 v1, v12
    ds_read_b128 v[132:135], v1
    v_add_u32 v1, v1, v13
    ds_read_b128 v[128:131], v1
    v_add_u32 v1, v1, v13
    ds_read_b128 v[124:127], v1
    v_add_u32 v1, v1, v13
    ds_read_b128 v[120:123], v1
    v_add_u32 v1, v1, v13
    ds_read_b128 v[116:119], v1
    v_add_u32 v1, v1, v13
    ds_read_b128 v[112:115], v1
    v_add_u32 v1, v1, v13
    ds_read_b128 v[108:111], v1
    v_add_u32 v1, v1, v13
    ds_read_b128 v[104:107], v1
Lhave_kv:
    s_waitcnt lgkmcnt(6)
Lkv_first:
    v_mfma_f32_32x32x16_bf16 v[66:81], v[132:135], v[164:167], 0
    v_mfma_f32_32x32x16_bf16 v[50:65], v[128:131], v[160:163], 0
    s_waitcnt lgkmcnt(0)
    v_max3_u32 v1, v132, v133, v134
    v_max3_u32 v1, v1, v135, v128
    v_max3_u32 v1, v1, v129, v130
    v_max3_u32 v1, v1, v131, v124
    v_max3_u32 v1, v1, v125, v126
    v_max3_u32 v1, v1, v127, v120
    v_max3_u32 v1, v1, v121, v122
    v_max3_u32 v1, v1, v123, v116
    v_max3_u32 v1, v1, v117, v118
    v_max3_u32 v1, v1, v119, v112
    v_max3_u32 v1, v1, v113, v114
    v_max3_u32 v1, v1, v115, v108
    v_max3_u32 v1, v1, v109, v110
    v_max3_u32 v1, v1, v111, v104
    v_max3_u32 v1, v1, v105, v106
    v_max_u32 v1, v1, v107
    v_cmp_eq_u32 vcc, -1, v1
    s_cbranch_vccnz Lkv_slow
Lkv_ok:
    ds_read_b64_tr_b16 v[96:97], v14 offset:16384
    ds_read_b64_tr_b16 v[98:99], v14 offset:17408
    ds_read_b64_tr_b16 v[46:47], v14 offset:20480
    ds_read_b64_tr_b16 v[48:49], v14 offset:21504
    ds_read_b64_tr_b16 v[42:43], v14 offset:24576
    ds_read_b64_tr_b16 v[44:45], v14 offset:25600
    ds_read_b64_tr_b16 v[38:39], v14 offset:28672
    ds_read_b64_tr_b16 v[40:41], v14 offset:29696
    v_add_f32 v74, 0x358637bd, v74
    v_rcp_f32 v74, v74
    ds_read_b64_tr_b16 v[132:133], v14 offset:32768
    ds_read_b64_tr_b16 v[134:135], v14 offset:33792
    v_mul_f32 v74, v74, v9
    v_mul_f32 v66, v66, v74
    v_mul_f32 v67, v67, v74
    v_mul_f32 v68, v68, v74
    v_mul_f32 v69, v69, v74
    v_mul_f32 v70, v70, v74
    v_mul_f32 v71, v71, v74
    v_mul_f32 v72, v72, v74
    v_mul_f32 v73, v73, v74
    v_cvt_pk_bf16_f32 v164, v66, v67
    v_cvt_pk_bf16_f32 v165, v68, v69
    v_cvt_pk_bf16_f32 v166, v70, v71
    v_cvt_pk_bf16_f32 v167, v72, v73
    v_mfma_f32_32x32x16_bf16 v[66:81], v[124:127], v[156:159], 0
    ds_read_b64_tr_b16 v[124:125], v14 offset:40960
    ds_read_b64_tr_b16 v[126:127], v14 offset:41984
    ds_write_b128 v10, v[164:167] offset:0
    v_add_f32 v58, 0x358637bd, v58
    v_rcp_f32 v58, v58
    ds_read_b64_tr_b16 v[128:129], v14 offset:36864
    ds_read_b64_tr_b16 v[130:131], v14 offset:37888
    v_mul_f32 v58, v58, v9
    v_mul_f32 v50, v50, v58
    v_mul_f32 v51, v51, v58
    v_mul_f32 v52, v52, v58
    v_mul_f32 v53, v53, v58
    v_mul_f32 v54, v54, v58
    v_mul_f32 v55, v55, v58
    v_mul_f32 v56, v56, v58
    v_mul_f32 v57, v57, v58
    v_cvt_pk_bf16_f32 v160, v50, v51
    v_cvt_pk_bf16_f32 v161, v52, v53
    v_cvt_pk_bf16_f32 v162, v54, v55
    v_cvt_pk_bf16_f32 v163, v56, v57
    v_mfma_f32_32x32x16_bf16 v[50:65], v[120:123], v[152:155], 0
    ds_read_b64_tr_b16 v[120:121], v14 offset:45056
    ds_read_b64_tr_b16 v[122:123], v14 offset:46080
    ds_write_b128 v10, v[160:163] offset:1024
    v_add_f32 v74, 0x358637bd, v74
    v_rcp_f32 v74, v74
    s_nop 0
    v_mul_f32 v74, v74, v9
    v_mul_f32 v66, v66, v74
    v_mul_f32 v67, v67, v74
    v_mul_f32 v68, v68, v74
    v_mul_f32 v69, v69, v74
    v_mul_f32 v70, v70, v74
    v_mul_f32 v71, v71, v74
    v_mul_f32 v72, v72, v74
    v_mul_f32 v73, v73, v74
    v_cvt_pk_bf16_f32 v156, v66, v67
    v_cvt_pk_bf16_f32 v157, v68, v69
    v_cvt_pk_bf16_f32 v158, v70, v71
    v_cvt_pk_bf16_f32 v159, v72, v73
    v_mfma_f32_32x32x16_bf16 v[66:81], v[116:119], v[148:151], 0
    ds_read_b64_tr_b16 v[116:117], v14 offset:49152
    ds_read_b64_tr_b16 v[118:119], v14 offset:50176
    ds_write_b128 v10, v[156:159] offset:2048
    v_add_f32 v58, 0x358637bd, v58
    v_rcp_f32 v58, v58
    s_nop 0
    v_mul_f32 v58, v58, v9
    v_mul_f32 v50, v50, v58
    v_mul_f32 v51, v51, v58
    v_mul_f32 v52, v52, v58
    v_mul_f32 v53, v53, v58
    v_mul_f32 v54, v54, v58
    v_mul_f32 v55, v55, v58
    v_mul_f32 v56, v56, v58
    v_mul_f32 v57, v57, v58
    v_cvt_pk_bf16_f32 v152, v50, v51
    v_cvt_pk_bf16_f32 v153, v52, v53
    v_cvt_pk_bf16_f32 v154, v54, v55
    v_cvt_pk_bf16_f32 v155, v56, v57
    v_mfma_f32_32x32x16_bf16 v[50:65], v[112:115], v[144:147], 0
    ds_read_b64_tr_b16 v[112:113], v14 offset:53248
    ds_read_b64_tr_b16 v[114:115], v14 offset:54272
    ds_write_b128 v10, v[152:155] offset:3072
    v_add_f32 v74, 0x358637bd, v74
    v_rcp_f32 v74, v74
    s_nop 0
    v_mul_f32 v74, v74, v9
    v_mul_f32 v66, v66, v74
    v_mul_f32 v67, v67, v74
    v_mul_f32 v68, v68, v74
    v_mul_f32 v69, v69, v74
    v_mul_f32 v70, v70, v74
    v_mul_f32 v71, v71, v74
    v_mul_f32 v72, v72, v74
    v_mul_f32 v73, v73, v74
    v_cvt_pk_bf16_f32 v148, v66, v67
    v_cvt_pk_bf16_f32 v149, v68, v69
    v_cvt_pk_bf16_f32 v150, v70, v71
    v_cvt_pk_bf16_f32 v151, v72, v73
    v_mfma_f32_32x32x16_bf16 v[66:81], v[108:111], v[140:143], 0
    ds_read_b64_tr_b16 v[108:109], v14 offset:57344
    ds_read_b64_tr_b16 v[110:111], v14 offset:58368
    ds_write_b128 v10, v[148:151] offset:4096
    v_add_f32 v58, 0x358637bd, v58
    v_rcp_f32 v58, v58
    s_nop 0
    v_mul_f32 v58, v58, v9
    v_mul_f32 v50, v50, v58
    v_mul_f32 v51, v51, v58
    v_mul_f32 v52, v52, v58
    v_mul_f32 v53, v53, v58
    v_mul_f32 v54, v54, v58
    v_mul_f32 v55, v55, v58
    v_mul_f32 v56, v56, v58
    v_mul_f32 v57, v57, v58
    v_cvt_pk_bf16_f32 v144, v50, v51
    v_cvt_pk_bf16_f32 v145, v52, v53
    v_cvt_pk_bf16_f32 v146, v54, v55
    v_cvt_pk_bf16_f32 v147, v56, v57
    v_mfma_f32_32x32x16_bf16 v[50:65], v[104:107], v[136:139], 0
    ds_read_b64_tr_b16 v[104:105], v14 offset:61440
    ds_read_b64_tr_b16 v[106:107], v14 offset:62464
    ds_write_b128 v10, v[144:147] offset:5120
    v_add_f32 v74, 0x358637bd, v74
    v_rcp_f32 v74, v74
    s_nop 0
    v_mul_f32 v74, v74, v9
    v_mul_f32 v66, v66, v74
    v_mul_f32 v67, v67, v74
    v_mul_f32 v68, v68, v74
    v_mul_f32 v69, v69, v74
    v_mul_f32 v70, v70, v74
    v_mul_f32 v71, v71, v74
    v_mul_f32 v72, v72, v74
    v_mul_f32 v73, v73, v74
    v_cvt_pk_bf16_f32 v140, v66, v67
    v_cvt_pk_bf16_f32 v141, v68, v69
    v_cvt_pk_bf16_f32 v142, v70, v71
    v_cvt_pk_bf16_f32 v143, v72, v73
    ds_write_b128 v10, v[140:143] offset:6144
    v_add_f32 v58, 0x358637bd, v58
    v_rcp_f32 v58, v58
    s_nop 0
    v_mul_f32 v58, v58, v9
    v_mul_f32 v50, v50, v58
    v_mul_f32 v51, v51, v58
    v_mul_f32 v52, v52, v58
    v_mul_f32 v53, v53, v58
    v_mul_f32 v54, v54, v58
    v_mul_f32 v55, v55, v58
    v_mul_f32 v56, v56, v58
    v_mul_f32 v57, v57, v58
    v_cvt_pk_bf16_f32 v136, v50, v51
    v_cvt_pk_bf16_f32 v137, v52, v53
    v_cvt_pk_bf16_f32 v138, v54, v55
    v_cvt_pk_bf16_f32 v139, v56, v57
    ds_write_b128 v10, v[136:139] offset:7168
    s_waitcnt lgkmcnt(0)
    s_barrier
    ds_read_b128 v[164:167], v15 offset:0
    ds_read_b128 v[160:163], v15 offset:256
    ds_read_b128 v[156:159], v15 offset:2048
    ds_read_b128 v[152:155], v15 offset:2304
    ds_read_b128 v[148:151], v15 offset:4096
    ds_read_b128 v[144:147], v15 offset:4352
    ds_read_b128 v[140:143], v15 offset:6144
    ds_read_b128 v[136:139], v15 offset:6400
    ds_read_b128 v[66:69], v15 offset:8192
    ds_read_b128 v[70:73], v15 offset:8448
    ds_read_b128 v[74:77], v15 offset:10240
    ds_read_b128 v[78:81], v15 offset:10496
    s_waitcnt lgkmcnt(11)
    v_mfma_f32_16x16x32_bf16 v[18:21], v[100:103], v[164:167], 0
    ds_read_b128 v[50:53], v15 offset:12288
    s_waitcnt lgkmcnt(11)
    v_mfma_f32_16x16x32_bf16 v[22:25], v[100:103], v[160:163], 0
    ds_read_b128 v[54:57], v15 offset:12544
    s_waitcnt lgkmcnt(11)
    v_mfma_f32_16x16x32_bf16 v[18:21], v[90:93], v[156:159], v[18:21]
    ds_read_b128 v[58:61], v15 offset:14336
    s_waitcnt lgkmcnt(11)
    v_mfma_f32_16x16x32_bf16 v[22:25], v[90:93], v[152:155], v[22:25]
    ds_read_b128 v[62:65], v15 offset:14592
    global_load_dwordx4 v[26:29], v17, s[22:23] sc1
    s_waitcnt lgkmcnt(11)
    v_mfma_f32_16x16x32_bf16 v[18:21], v[86:89], v[148:151], v[18:21]
    ds_read_b128 v[164:167], v15 offset:16384
    s_waitcnt lgkmcnt(11)
    v_mfma_f32_16x16x32_bf16 v[22:25], v[86:89], v[144:147], v[22:25]
    ds_read_b128 v[160:163], v15 offset:16640
    s_waitcnt lgkmcnt(11)
    v_mfma_f32_16x16x32_bf16 v[18:21], v[82:85], v[140:143], v[18:21]
    ds_read_b128 v[156:159], v15 offset:18432
    s_waitcnt lgkmcnt(11)
    v_mfma_f32_16x16x32_bf16 v[22:25], v[82:85], v[136:139], v[22:25]
    ds_read_b128 v[152:155], v15 offset:18688
    s_waitcnt lgkmcnt(11)
    v_mfma_f32_16x16x32_bf16 v[18:21], v[96:99], v[66:69], v[18:21]
    ds_read_b128 v[148:151], v15 offset:20480
    s_waitcnt lgkmcnt(11)
    v_mfma_f32_16x16x32_bf16 v[22:25], v[96:99], v[70:73], v[22:25]
    ds_read_b128 v[144:147], v15 offset:20736
    s_waitcnt lgkmcnt(11)
    v_mfma_f32_16x16x32_bf16 v[18:21], v[46:49], v[74:77], v[18:21]
    ds_read_b128 v[140:143], v15 offset:22528
    s_waitcnt lgkmcnt(11)
    v_mfma_f32_16x16x32_bf16 v[22:25], v[46:49], v[78:81], v[22:25]
    ds_read_b128 v[136:139], v15 offset:22784
    s_waitcnt lgkmcnt(11)
    v_mfma_f32_16x16x32_bf16 v[18:21], v[42:45], v[50:53], v[18:21]
    ds_read_b128 v[66:69], v15 offset:24576
    s_waitcnt lgkmcnt(11)
    v_mfma_f32_16x16x32_bf16 v[22:25], v[42:45], v[54:57], v[22:25]
    ds_read_b128 v[70:73], v15 offset:24832
    s_waitcnt lgkmcnt(11)
    v_mfma_f32_16x16x32_bf16 v[18:21], v[38:41], v[58:61], v[18:21]
    ds_read_b128 v[74:77], v15 offset:26624
    s_waitcnt lgkmcnt(11)
    v_mfma_f32_16x16x32_bf16 v[22:25], v[38:41], v[62:65], v[22:25]
    ds_read_b128 v[78:81], v15 offset:26880
    s_waitcnt lgkmcnt(11)
    v_mfma_f32_16x16x32_bf16 v[18:21], v[132:135], v[164:167], v[18:21]
    ds_read_b128 v[50:53], v15 offset:28672
    s_waitcnt lgkmcnt(11)
    v_mfma_f32_16x16x32_bf16 v[22:25], v[132:135], v[160:163], v[22:25]
    ds_read_b128 v[54:57], v15 offset:28928
    s_waitcnt lgkmcnt(11)
    v_mfma_f32_16x16x32_bf16 v[18:21], v[128:131], v[156:159], v[18:21]
    ds_read_b128 v[58:61], v15 offset:30720
    s_waitcnt lgkmcnt(11)
    v_mfma_f32_16x16x32_bf16 v[22:25], v[128:131], v[152:155], v[22:25]
    ds_read_b128 v[62:65], v15 offset:30976
    s_waitcnt lgkmcnt(11)
    v_mfma_f32_16x16x32_bf16 v[18:21], v[124:127], v[148:151], v[18:21]
    s_waitcnt lgkmcnt(10)
    v_mfma_f32_16x16x32_bf16 v[22:25], v[124:127], v[144:147], v[22:25]
    s_waitcnt lgkmcnt(9)
    v_mfma_f32_16x16x32_bf16 v[18:21], v[120:123], v[140:143], v[18:21]
    s_waitcnt lgkmcnt(8)
    v_mfma_f32_16x16x32_bf16 v[22:25], v[120:123], v[136:139], v[22:25]
    s_waitcnt lgkmcnt(7)
    v_mfma_f32_16x16x32_bf16 v[18:21], v[116:119], v[66:69], v[18:21]
    s_waitcnt lgkmcnt(6)
    v_mfma_f32_16x16x32_bf16 v[22:25], v[116:119], v[70:73], v[22:25]
    s_waitcnt lgkmcnt(5)
    v_mfma_f32_16x16x32_bf16 v[18:21], v[112:115], v[74:77], v[18:21]
    s_waitcnt lgkmcnt(4)
    v_mfma_f32_16x16x32_bf16 v[22:25], v[112:115], v[78:81], v[22:25]
    s_waitcnt lgkmcnt(3)
    v_mfma_f32_16x16x32_bf16 v[18:21], v[108:111], v[50:53], v[18:21]
    s_waitcnt lgkmcnt(2)
    v_mfma_f32_16x16x32_bf16 v[22:25], v[108:111], v[54:57], v[22:25]
    s_waitcnt lgkmcnt(1)
    v_mfma_f32_16x16x32_bf16 v[18:21], v[104:107], v[58:61], v[18:21]
    s_waitcnt lgkmcnt(0)
    v_mfma_f32_16x16x32_bf16 v[22:25], v[104:107], v[62:65], v[22:25]
    s_branch Lx3_first
Lx3:
    global_load_dwordx4 v[26:29], v17, s[22:23] sc1
Lx3_first:
    s_waitcnt vmcnt(0)
    v_and_b32 v1, 0x10000, v26
    v_cmp_eq_u32 vcc, 0, v1
    s_cbranch_vccz Lx3_ok
    s_cmp_eq_u32 s32, 0
    s_cbranch_scc1 Lx3_ok
    s_sub_u32 s32, s32, 1
    s_sleep 2
    s_branch Lx3
Lx3_ok:
    v_permlane16_swap_b32 v26, v28
    v_permlane16_swap_b32 v27, v29
    v_lshlrev_b32 v50, 16, v26
    v_and_b32 v51, 0xffff0000, v26
    v_lshlrev_b32 v52, 16, v27
    v_and_b32 v53, 0xffff0000, v27
    v_lshlrev_b32 v54, 16, v28
    v_and_b32 v55, 0xffff0000, v28
    v_lshlrev_b32 v56, 16, v29
    v_and_b32 v57, 0xffff0000, v29
    v_pk_add_f32 v[18:19], v[18:19], v[50:51]
    v_pk_add_f32 v[20:21], v[20:21], v[52:53]
    v_pk_add_f32 v[22:23], v[22:23], v[54:55]
    v_pk_add_f32 v[24:25], v[24:25], v[56:57]
    v_cvt_pk_bf16_f32 v26, v18, v19
    v_cvt_pk_bf16_f32 v27, v20, v21
    v_cvt_pk_bf16_f32 v28, v22, v23
    v_cvt_pk_bf16_f32 v29, v24, v25
    s_nop 0
    v_permlane16_swap_b32 v26, v28
    v_permlane16_swap_b32 v27, v29
    global_store_dwordx4 v16, v[26:29], s[18:19]
    s_endpgm
Lsp_rd:
    v_add_u32 v1, 156928, v8
    ds_read_b128 v[58:61], v1 offset:0
    ds_read_b128 v[62:65], v1 offset:1024
    ds_read_b128 v[46:49], v1 offset:2048
    ds_read_b128 v[50:53], v1 offset:3072
    s_nop 3
    s_branch Lsp_now
Lsp:
    s_nop 7
    v_fma_f32 v46, v42, v58, v46
    v_fma_f32 v50, v54, v58, v50
    v_fma_f32 v46, -v54, v62, v46
    v_fma_f32 v50, v42, v62, v50
    v_cvt_pk_bf16_f32 v20, v46, v50
    v_fma_f32 v47, v43, v59, v47
    v_fma_f32 v51, v55, v59, v51
    v_fma_f32 v47, -v55, v63, v47
    v_fma_f32 v51, v43, v63, v51
    v_cvt_pk_bf16_f32 v21, v47, v51
    v_fma_f32 v48, v44, v60, v48
    v_fma_f32 v52, v56, v60, v52
    v_fma_f32 v48, -v56, v64, v48
    v_fma_f32 v52, v44, v64, v52
    v_cvt_pk_bf16_f32 v22, v48, v52
    v_fma_f32 v49, v45, v61, v49
    v_fma_f32 v53, v57, v61, v53
    v_fma_f32 v49, -v57, v65, v49
    v_fma_f32 v53, v45, v65, v53
    v_cvt_pk_bf16_f32 v23, v49, v53
    s_nop 1
    s_branch Lspj
Lkv_slow:
    s_cmp_eq_u32 s32, 0
    s_cbranch_scc1 Lkv_ok
    s_sub_u32 s32, s32, 1
    s_sleep 4
    v_subrev_u32 v1, 139392, v12
    v_bfe_u32 v2, v1, 8, 1
    v_lshlrev_b32 v2, 4, v2
    v_xor_b32 v1, v1, v2
    v_add_u32 v1, 8388608, v1
    global_load_dwordx4 v[132:135], v1, s[22:23] sc1
    v_add_u32 v1, v1, v13
    global_load_dwordx4 v[128:131], v1, s[22:23] sc1
    v_add_u32 v1, v1, v13
    global_load_dwordx4 v[124:127], v1, s[22:23] sc1
    v_add_u32 v1, v1, v13
    global_load_dwordx4 v[120:123], v1, s[22:23] sc1
    v_add_u32 v1, v1, v13
    global_load_dwordx4 v[116:119], v1, s[22:23] sc1
    v_add_u32 v1, v1, v13
    global_load_dwordx4 v[112:115], v1, s[22:23] sc1
    v_add_u32 v1, v1, v13
    global_load_dwordx4 v[108:111], v1, s[22:23] sc1
    v_add_u32 v1, v1, v13
    global_load_dwordx4 v[104:107], v1, s[22:23] sc1
    s_waitcnt vmcnt(0)
    s_branch Lkv_first
Lloader2:
    s_mov_b32 s52, s14
    s_mov_b32 s53, s15
    s_mov_b32 s54, 524288
    s_mov_b32 s55, 0x20000
    s_lshl_b32 s30, s29, 1
    s_add_u32 s30, s30, s33
    s_lshl_b32 s30, s30, 13
    s_and_b32 s31, s26, 4
    s_lshl_b32 s31, s31, 7
    s_add_u32 s30, s30, s31
    v_lshrrev_b32 v1, 2, v5
    v_lshlrev_b32 v1, 10, v1
    v_and_b32 v17, 3, v5
    v_lshl_add_u32 v1, v17, 7, v1
    s_mov_b32 exec_hi, 0
    buffer_load_dword v17, v1, s[52:55], s30 offen
    s_mov_b64 exec, -1
    v_lshl_add_u32 v1, v5, 3, s28
    v_mul_u32_u24 v1, 514, v1
    s_lshl_b32 s31, s29, 4
    v_add_u32 v14, s31, v1
    s_cmp_eq_u32 s33, 0
    s_cselect_b64 s[10:11], s[6:7], s[8:9]
    s_lshl_b32 s38, s33, 12
    s_add_u32 s38, s38, 147712
    s_add_u32 s30, s29, 0
    s_and_b32 s30, s30, 3
    s_mul_i32 s35, s30, 263168
    s_lshl_b32 s30, s30, 10
    s_add_u32 m0, s38, s30
    v_add_u32 v15, s35, v14
    global_load_lds_dwordx4 v15, s[10:11]
    s_add_u32 s30, s29, 1
    s_and_b32 s30, s30, 3
    s_mul_i32 s35, s30, 263168
    s_lshl_b32 s30, s30, 10
    s_add_u32 m0, s38, s30
    v_add_u32 v15, s35, v14
    global_load_lds_dwordx4 v15, s[10:11]
    v_lshlrev_b32 v1, 1, v7
    v_xor_b32 v1, v1, v5
    v_and_b32 v1, 7, v1
    v_lshlrev_b32 v16, 10, v2
    v_lshl_add_u32 v16, v1, 4, v16
    s_lshl_b32 s30, s26, 7
    s_lshl_b32 s31, s33, 13
    s_add_u32 s31, s31, s30
    v_add_u32 v16, s31, v16
    v_lshrrev_b32 v2, 1, v5
    v_lshrrev_b32 v1, 3, v5
    v_xor_b32 v1, v1, v5
    v_and_b32 v1, 1, v1
    v_lshl_add_u32 v1, v2, 2, v1
    s_lshl_b32 s30, s28, 4
    s_lshr_b32 s31, s29, 1
    s_add_u32 s39, s30, s31
    s_mul_i32 s30, s39, 16512
    s_lshl_b32 s31, s33, 13
    s_add_u32 s30, s30, s31
    s_and_b32 s31, s29, 1
    s_lshl_b32 s31, s31, 5
    s_add_u32 s30, s30, s31
    v_lshl_add_u32 v13, v1, 4, s30
    s_waitcnt vmcnt(3)
    s_barrier
    s_branch LwF__7f
LwF__7:
    s_sleep 1
LwF__7f:
    ds_read_b32 v2, v3 offset:24
    s_waitcnt lgkmcnt(0)
    v_cmp_gt_u32 vcc, 2, v2
    s_cbranch_vccnz LwF__7
    s_lshl_b32 s31, s33, 12
    s_add_u32 m0, s31, 131072
    s_nop 0
    global_load_lds_dwordx4 v13, s[22:23] sc1
    s_add_u32 m0, m0, 1024
    v_add_u32 v13, 2048, v13
    global_load_lds_dwordx4 v13, s[22:23] sc1
    s_add_u32 m0, m0, 1024
    v_add_u32 v13, 2048, v13
    global_load_lds_dwordx4 v13, s[22:23] sc1
    s_add_u32 m0, m0, 1024
    v_add_u32 v13, 2048, v13
    global_load_lds_dwordx4 v13, s[22:23] sc1
    s_add_u32 s30, s29, 2
    s_and_b32 s30, s30, 3
    s_mul_i32 s35, s30, 263168
    s_lshl_b32 s30, s30, 10
    s_add_u32 m0, s38, s30
    v_add_u32 v15, s35, v14
    global_load_lds_dwordx4 v15, s[10:11]
    s_add_u32 s30, s29, 3
    s_and_b32 s30, s30, 3
    s_mul_i32 s35, s30, 263168
    s_lshl_b32 s30, s30, 10
    s_add_u32 m0, s38, s30
    v_add_u32 v15, s35, v14
    global_load_lds_dwordx4 v15, s[10:11]
    s_lshl_b32 s30, s25, 1
    s_add_u32 s30, s30, s33
    s_lshl_b32 s30, s30, 15
    s_add_u32 s30, s30, 6291456
    v_add_u32 v18, s30, v8
    s_waitcnt vmcnt(2)
    s_lshl_b32 s30, s39, 7
    s_add_u32 s30, s30, 8880128
    s_add_u32 s10, s22, s30
    s_addc_u32 s11, s23, 0
    s_atomic_add s3, s[10:11], 0
    s_waitcnt vmcnt(0)
    s_mov_b64 exec, 1
    ds_add_u32 v3, v4 offset:28
    s_mov_b64 exec, -1
    s_setprio 3
    s_branch LwE__8f
LwE__8:
    s_sleep 1
LwE__8f:
    ds_read_b32 v2, v3 offset:16
    s_waitcnt lgkmcnt(0)
    v_cmp_gt_u32 vcc, 8, v2
    s_cbranch_vccnz LwE__8
    s_mov_b32 s35, 0
    s_add_u32 m0, s34, 0
    s_nop 0
    buffer_load_dwordx4 v16, s[52:55], s35 offen lds
    s_add_u32 m0, m0, 2048
    s_add_u32 s35, s35, 16384
    buffer_load_dwordx4 v16, s[52:55], s35 offen lds
    s_add_u32 m0, m0, 2048
    s_add_u32 s35, s35, 16384
    buffer_load_dwordx4 v16, s[52:55], s35 offen lds
    s_add_u32 m0, m0, 2048
    s_add_u32 s35, s35, 16384
    buffer_load_dwordx4 v16, s[52:55], s35 offen lds
    s_mov_b32 s35, 65536
    s_add_u32 m0, s34, 8192
    s_nop 0
    buffer_load_dwordx4 v16, s[52:55], s35 offen lds
    s_add_u32 m0, m0, 2048
    s_add_u32 s35, s35, 16384
    buffer_load_dwordx4 v16, s[52:55], s35 offen lds
    s_add_u32 m0, m0, 2048
    s_add_u32 s35, s35, 16384
    buffer_load_dwordx4 v16, s[52:55], s35 offen lds
    s_add_u32 m0, m0, 2048
    s_add_u32 s35, s35, 16384
    buffer_load_dwordx4 v16, s[52:55], s35 offen lds
    s_mov_b32 s35, 131072
    s_add_u32 m0, s34, 16384
    s_nop 0
    buffer_load_dwordx4 v16, s[52:55], s35 offen lds
    s_add_u32 m0, m0, 2048
    s_add_u32 s35, s35, 16384
    buffer_load_dwordx4 v16, s[52:55], s35 offen lds
    s_add_u32 m0, m0, 2048
    s_add_u32 s35, s35, 16384
    buffer_load_dwordx4 v16, s[52:55], s35 offen lds
    s_add_u32 m0, m0, 2048
    s_add_u32 s35, s35, 16384
    buffer_load_dwordx4 v16, s[52:55], s35 offen lds
    s_mov_b32 s35, 196608
    s_add_u32 m0, s34, 24576
    s_nop 0
    buffer_load_dwordx4 v16, s[52:55], s35 offen lds
    s_add_u32 m0, m0, 2048
    s_add_u32 s35, s35, 16384
    buffer_load_dwordx4 v16, s[52:55], s35 offen lds
    s_add_u32 m0, m0, 2048
    s_add_u32 s35, s35, 16384
    buffer_load_dwordx4 v16, s[52:55], s35 offen lds
    s_add_u32 m0, m0, 2048
    s_add_u32 s35, s35, 16384
    buffer_load_dwordx4 v16, s[52:55], s35 offen lds
    s_cmp_eq_u32 s33, 0
    s_cbranch_scc1 Lld0
    s_branch LwB2__9f
LwB2__9:
    s_sleep 1
LwB2__9f:
    ds_read_b32 v2, v3 offset:32
    s_waitcnt lgkmcnt(0)
    v_cmp_gt_u32 vcc, 9, v2
    s_cbranch_vccnz LwB2__9
    s_lshr_b32 s31, s2, 5
    s_lshl_b32 s30, s31, 7
    s_add_u32 s30, s30, 8847360
    s_add_u32 s10, s22, s30
    s_addc_u32 s11, s23, 0
    s_mov_b32 s31, 1
    s_atomic_add s31, s[10:11], 0 glc
    v_lshlrev_b32 v1, 7, v5
    v_add_u32 v1, 8863744, v1
    s_waitcnt lgkmcnt(0)
    s_cmp_lg_u32 s31, 31
    s_cbranch_scc1 Larr2_notlast
    global_atomic_add v1, v4, s[22:23] sc1
Larr2_notlast:
    s_branch Lld1
Lld0:
    s_lshl_b32 s30, s25, 7
    s_add_u32 s30, s30, 8849408
    s_add_u32 s10, s22, s30
    s_addc_u32 s11, s23, 0
    s_branch LwQ__10f
LwQ__10:
    s_sleep 1
LwQ__10f:
    ds_read_b32 v2, v3 offset:20
    s_waitcnt lgkmcnt(0)
    v_cmp_gt_u32 vcc, 8, v2
    s_cbranch_vccnz LwQ__10
    s_mov_b32 s36, 1
    s_atomic_add s36, s[10:11], 0 glc
Lld1:
    s_cmp_eq_u32 s33, 0
    s_cbranch_scc1 Lld2
LwS__11:
    ds_read_b32 v2, v3 offset:36
    s_waitcnt lgkmcnt(0)
    v_cmp_gt_u32 vcc, 8, v2
    s_cbranch_vccnz LwS__11
Lld2:
    s_mov_b32 s35, 262144
    s_add_u32 m0, s34, 32768
    s_nop 0
    buffer_load_dwordx4 v16, s[52:55], s35 offen lds
    s_add_u32 m0, m0, 2048
    s_add_u32 s35, s35, 16384
    buffer_load_dwordx4 v16, s[52:55], s35 offen lds
    s_add_u32 m0, m0, 2048
    s_add_u32 s35, s35, 16384
    buffer_load_dwordx4 v16, s[52:55], s35 offen lds
    s_add_u32 m0, m0, 2048
    s_add_u32 s35, s35, 16384
    buffer_load_dwordx4 v16, s[52:55], s35 offen lds
    s_mov_b32 s35, 327680
    s_add_u32 m0, s34, 40960
    s_nop 0
    buffer_load_dwordx4 v16, s[52:55], s35 offen lds
    s_add_u32 m0, m0, 2048
    s_add_u32 s35, s35, 16384
    buffer_load_dwordx4 v16, s[52:55], s35 offen lds
    s_add_u32 m0, m0, 2048
    s_add_u32 s35, s35, 16384
    buffer_load_dwordx4 v16, s[52:55], s35 offen lds
    s_add_u32 m0, m0, 2048
    s_add_u32 s35, s35, 16384
    buffer_load_dwordx4 v16, s[52:55], s35 offen lds
    s_mov_b32 s35, 393216
    s_add_u32 m0, s34, 49152
    s_nop 0
    buffer_load_dwordx4 v16, s[52:55], s35 offen lds
    s_add_u32 m0, m0, 2048
    s_add_u32 s35, s35, 16384
    buffer_load_dwordx4 v16, s[52:55], s35 offen lds
    s_add_u32 m0, m0, 2048
    s_add_u32 s35, s35, 16384
    buffer_load_dwordx4 v16, s[52:55], s35 offen lds
    s_add_u32 m0, m0, 2048
    s_add_u32 s35, s35, 16384
    buffer_load_dwordx4 v16, s[52:55], s35 offen lds
    s_mov_b32 s35, 458752
    s_add_u32 m0, s34, 57344
    s_nop 0
    buffer_load_dwordx4 v16, s[52:55], s35 offen lds
    s_add_u32 m0, m0, 2048
    s_add_u32 s35, s35, 16384
    buffer_load_dwordx4 v16, s[52:55], s35 offen lds
    s_add_u32 m0, m0, 2048
    s_add_u32 s35, s35, 16384
    buffer_load_dwordx4 v16, s[52:55], s35 offen lds
    s_add_u32 m0, m0, 2048
    s_add_u32 s35, s35, 16384
    buffer_load_dwordx4 v16, s[52:55], s35 offen lds
    s_cmp_eq_u32 s33, 0
    s_cbranch_scc0 Lld3
    s_waitcnt lgkmcnt(0)
    s_cmp_ge_u32 s36, 7
    s_cbranch_scc1 Lfq_ok
Lfq:
    s_mov_b32 s31, 0
    s_atomic_or s31, s[10:11], 0 glc
    s_waitcnt lgkmcnt(0)
    s_cmp_ge_u32 s31, 8
    s_cbranch_scc1 Lfq_ok
    s_cmp_eq_u32 s32, 0
    s_cbranch_scc1 Lfq_ok
    s_sub_u32 s32, s32, 1
    s_sleep 1
    s_branch Lfq
Lfq_ok:
    s_mov_b64 exec, 1
    ds_add_u32 v3, v4 offset:44
    s_mov_b64 exec, -1
Lld3:
LwG__12:
    ds_read_b32 v2, v3 offset:44
    s_waitcnt lgkmcnt(0)
    v_cmp_gt_u32 vcc, 1, v2
    s_cbranch_vccnz LwG__12
    s_lshl_b32 s38, s33, 15
    s_add_u32 m0, s38, 65536
    s_nop 0
    global_load_lds_dwordx4 v18, s[22:23] offset:0 sc1
    global_load_lds_dwordx4 v18, s[22:23] offset:1024 sc1
    global_load_lds_dwordx4 v18, s[22:23] offset:2048 sc1
    global_load_lds_dwordx4 v18, s[22:23] offset:3072 sc1
    s_add_u32 m0, m0, 4096
    v_add_u32 v18, 4096, v18
    global_load_lds_dwordx4 v18, s[22:23] offset:0 sc1
    global_load_lds_dwordx4 v18, s[22:23] offset:1024 sc1
    global_load_lds_dwordx4 v18, s[22:23] offset:2048 sc1
    global_load_lds_dwordx4 v18, s[22:23] offset:3072 sc1
    s_add_u32 m0, m0, 4096
    v_add_u32 v18, 4096, v18
    global_load_lds_dwordx4 v18, s[22:23] offset:0 sc1
    global_load_lds_dwordx4 v18, s[22:23] offset:1024 sc1
    global_load_lds_dwordx4 v18, s[22:23] offset:2048 sc1
    global_load_lds_dwordx4 v18, s[22:23] offset:3072 sc1
    s_add_u32 m0, m0, 4096
    v_add_u32 v18, 4096, v18
    global_load_lds_dwordx4 v18, s[22:23] offset:0 sc1
    global_load_lds_dwordx4 v18, s[22:23] offset:1024 sc1
    global_load_lds_dwordx4 v18, s[22:23] offset:2048 sc1
    global_load_lds_dwordx4 v18, s[22:23] offset:3072 sc1
    s_add_u32 m0, m0, 4096
    v_add_u32 v18, 4096, v18
    global_load_lds_dwordx4 v18, s[22:23] offset:0 sc1
    global_load_lds_dwordx4 v18, s[22:23] offset:1024 sc1
    global_load_lds_dwordx4 v18, s[22:23] offset:2048 sc1
    global_load_lds_dwordx4 v18, s[22:23] offset:3072 sc1
    s_add_u32 m0, m0, 4096
    v_add_u32 v18, 4096, v18
    global_load_lds_dwordx4 v18, s[22:23] offset:0 sc1
    global_load_lds_dwordx4 v18, s[22:23] offset:1024 sc1
    global_load_lds_dwordx4 v18, s[22:23] offset:2048 sc1
    global_load_lds_dwordx4 v18, s[22:23] offset:3072 sc1
    s_add_u32 m0, m0, 4096
    v_add_u32 v18, 4096, v18
    global_load_lds_dwordx4 v18, s[22:23] offset:0 sc1
    global_load_lds_dwordx4 v18, s[22:23] offset:1024 sc1
    global_load_lds_dwordx4 v18, s[22:23] offset:2048 sc1
    global_load_lds_dwordx4 v18, s[22:23] offset:3072 sc1
    s_add_u32 m0, m0, 4096
    v_add_u32 v18, 4096, v18
    global_load_lds_dwordx4 v18, s[22:23] offset:0 sc1
    global_load_lds_dwordx4 v18, s[22:23] offset:1024 sc1
    global_load_lds_dwordx4 v18, s[22:23] offset:2048 sc1
    global_load_lds_dwordx4 v18, s[22:23] offset:3072 sc1
    s_waitcnt vmcnt(0)
    s_mov_b64 exec, 1
    ds_add_u32 v3, v4 offset:0
    s_mov_b64 exec, -1
    s_endpgm
Laux0:
    v_mov_b32 v28, -1
    v_mov_b32 v29, -1
    s_and_b32 s33, s25, 15
    s_cmp_eq_u32 s33, 5
    s_cselect_b32 s33, 1, 0
    s_lshl_b32 s30, s26, 5
    s_add_u32 s30, s30, s25
    s_mul_i32 s31, s30, 4352
    s_add_u32 s31, s31, 10485760
    v_lshlrev_b32 v19, 6, v6
    v_lshl_add_u32 v19, v7, 4, v19
    v_add_u32 v19, s31, v19
    s_add_u32 s31, s31, 4096
    v_add_u32 v10, s31, v8
    s_lshl_b32 s30, s30, 6
    s_add_u32 s30, s30, 8388608
    v_lshl_add_u32 v14, v5, 3, s30
    s_lshl_b32 s30, s26, 1
    s_lshr_b32 s31, s25, 4
    s_add_u32 s30, s30, s31
    s_lshl_b32 s30, s30, 6
    s_add_u32 s30, s30, 8404992
    v_lshl_add_u32 v15, v5, 3, s30
    v_lshrrev_b32 v1, 3, v5
    v_mul_u32_u24 v1, 4352, v1
    v_and_b32 v2, 7, v5
    v_lshl_add_u32 v1, v2, 4, v1
    s_mul_i32 s30, s26, 139264
    s_add_u32 s30, s30, 10485760
    s_lshl_b32 s31, s31, 7
    s_add_u32 s31, s31, 4096
    s_add_u32 s31, s31, s30
    v_add_u32 v17, s31, v1
    s_lshl_b32 s31, s25, 7
    s_add_u32 s31, s31, s30
    v_add_u32 v16, s31, v1
    v_add_u32 v13, 8519680, v8
    v_lshlrev_b32 v2, 4, v2
    v_lshrrev_b32 v1, 3, v5
    v_lshl_add_u32 v1, v1, 10, v2
    v_add_u32 v20, 131072, v1
    v_add_u32 v18, 155904, v2
    s_barrier
    v_mov_b32 v1, 0
    global_load_dword v12, v1, s[20:21] sc1
    s_lshl_b32 s30, s2, 8
    s_add_u32 s30, s30, 8847360
    v_lshl_add_u32 v2, v5, 2, s30
    global_store_dword v2, v1, s[22:23] sc1
    s_mov_b64 exec, 0xff
    global_store_dwordx2 v14, v[28:29], s[22:23] sc1
    s_cmp_eq_u32 s33, 0
    s_cbranch_scc1 Lclr_skip
    global_store_dwordx2 v15, v[28:29], s[22:23] sc1
Lclr_skip:
    s_mov_b64 exec, -1
    s_setprio 0
    ds_read_b128 v[104:107], v20 offset:0
    ds_read_b128 v[108:111], v20 offset:128
    ds_read_b128 v[112:115], v20 offset:256
    ds_read_b128 v[116:119], v20 offset:384
    ds_read_b128 v[120:123], v20 offset:512
    ds_read_b128 v[124:127], v20 offset:640
    ds_read_b128 v[128:131], v20 offset:768
    ds_read_b128 v[132:135], v20 offset:896
    s_waitcnt vmcnt(3)
    ds_read_b128 v[72:75], v18 offset:0
    ds_read_b128 v[76:79], v18 offset:128
    ds_read_b128 v[80:83], v18 offset:256
    ds_read_b128 v[84:87], v18 offset:384
    ds_read_b128 v[88:91], v18 offset:512
    ds_read_b128 v[92:95], v18 offset:640
    ds_read_b128 v[96:99], v18 offset:768
    ds_read_b128 v[100:103], v18 offset:896
    v_mov_b32 v20, 0
    s_waitcnt lgkmcnt(0)
    v_dot2c_f32_bf16 v20, v104, v72
    v_dot2c_f32_bf16 v20, v105, v73
    v_dot2c_f32_bf16 v20, v106, v74
    v_dot2c_f32_bf16 v20, v107, v75
    v_dot2c_f32_bf16 v20, v108, v76
    v_dot2c_f32_bf16 v20, v109, v77
    v_dot2c_f32_bf16 v20, v110, v78
    v_dot2c_f32_bf16 v20, v111, v79
    v_dot2c_f32_bf16 v20, v112, v80
    v_dot2c_f32_bf16 v20, v113, v81
    v_dot2c_f32_bf16 v20, v114, v82
    v_dot2c_f32_bf16 v20, v115, v83
    v_dot2c_f32_bf16 v20, v116, v84
    v_dot2c_f32_bf16 v20, v117, v85
    v_dot2c_f32_bf16 v20, v118, v86
    v_dot2c_f32_bf16 v20, v119, v87
    v_dot2c_f32_bf16 v20, v120, v88
    v_dot2c_f32_bf16 v20, v121, v89
    v_dot2c_f32_bf16 v20, v122, v90
    v_dot2c_f32_bf16 v20, v123, v91
    v_dot2c_f32_bf16 v20, v124, v92
    v_dot2c_f32_bf16 v20, v125, v93
    v_dot2c_f32_bf16 v20, v126, v94
    v_dot2c_f32_bf16 v20, v127, v95
    v_dot2c_f32_bf16 v20, v128, v96
    v_dot2c_f32_bf16 v20, v129, v97
    v_dot2c_f32_bf16 v20, v130, v98
    v_dot2c_f32_bf16 v20, v131, v99
    v_dot2c_f32_bf16 v20, v132, v100
    v_dot2c_f32_bf16 v20, v133, v101
    v_dot2c_f32_bf16 v20, v134, v102
    v_dot2c_f32_bf16 v20, v135, v103
    s_nop 2
    v_add_f32_dpp v20, v20, v20 quad_perm:[1,0,3,2] row_mask:0xf bank_mask:0xf
    s_nop 1
    v_add_f32_dpp v20, v20, v20 quad_perm:[2,3,0,1] row_mask:0xf bank_mask:0xf
    s_nop 1
    v_add_f32_dpp v20, v20, v20 row_half_mirror row_mask:0xf bank_mask:0xf
    v_mul_f32 v20, 0xbfb8aa3b, v20
    v_exp_f32 v20, v20
    s_nop 0
    v_add_f32 v20, 1.0, v20
    v_rcp_f32 v20, v20
    v_lshrrev_b32 v1, 3, v5
    v_lshlrev_b32 v1, 2, v1
    v_add_u32 v2, 162560, v1
    ds_write_b32 v2, v20
    v_and_b32 v2, 1, v5
    v_lshl_add_u32 v1, v2, 5, v1
    s_lshl_b32 s30, s27, 6
    s_add_u32 s30, s30, 8454144
    v_add_u32 v1, s30, v1
    s_setprio 3
    s_mov_b32 exec_lo, 0x03030303
    s_mov_b32 exec_hi, 0x03030303
    global_store_dword v1, v20, s[22:23] sc1
    s_mov_b64 exec, -1
    s_waitcnt lgkmcnt(0)
    s_barrier
    s_barrier
    s_branch Lnv0_first
Lnv0:
    v_mov_b32 v1, 0
    global_load_dword v12, v1, s[20:21] sc1
Lnv0_first:
    s_waitcnt vmcnt(0)
    v_cmp_eq_u32 vcc, 0, v12
    s_cbranch_vccz Lnv0_ok
    s_cmp_eq_u32 s32, 0
    s_cbranch_scc1 Lnv0_ok
    s_sub_u32 s32, s32, 1
    s_sleep 4
    s_branch Lnv0
Lnv0_ok:
    v_lshrrev_b32 v24, 0, v12
    v_lshrrev_b32 v25, 8, v12
    v_lshrrev_b32 v26, 16, v12
    v_lshrrev_b32 v27, 24, v12
    s_barrier
    s_lshl_b32 s30, s27, 4
    s_add_u32 s30, s30, 8519680
    v_mov_b32 v1, s30
    s_mov_b64 exec, 1
    global_store_dword v1, v12, s[22:23] sc1
    s_mov_b64 exec, -1
    s_barrier
    s_barrier
    s_barrier
    s_barrier
    global_load_dword v22, v13, s[22:23] offset:0 sc1
    global_load_dword v23, v13, s[22:23] offset:1024 sc1
    s_barrier
    s_branch Lf10_first
Lf10:
    global_load_dword v22, v13, s[22:23] offset:0 sc1
    global_load_dword v23, v13, s[22:23] offset:1024 sc1
Lf10_first:
    s_waitcnt vmcnt(0)
    v_xor_b32 v1, v12, v22
    v_bitop3_b32 v1, v1, v12, v23 bitop3:0xf6
    v_cmp_ne_u32 vcc, 0, v1
    s_cbranch_vccz Lf10_ok
    s_cmp_eq_u32 s32, 0
    s_cbranch_scc1 Lf10_ok
    s_sub_u32 s32, s32, 1
    s_sleep 8
    s_branch Lf10
Lf10_ok:
    s_mov_b64 exec, 1
    ds_add_u32 v3, v4 offset:24
    s_mov_b64 exec, -1
    s_branch LwF__13f
LwF__13:
    s_sleep 1
LwF__13f:
    ds_read_b32 v2, v3 offset:24
    s_waitcnt lgkmcnt(0)
    v_cmp_gt_u32 vcc, 2, v2
    s_cbranch_vccnz LwF__13
    v_add_u32 v18, 139392, v8
    v_add_u32 v20, 162048, v8
    s_lshl_b32 s30, s26, 10
    s_add_u32 s30, s30, 8855552
    v_lshl_add_u32 v13, v5, 7, s30
    s_movk_i32 s35, 0xff
    s_lshl_b32 s31, s26, 3
    s_and_b32 s30, s25, 7
    s_add_u32 s31, s31, s30
    s_lshl_b32 s30, s31, 7
    s_add_u32 s30, s30, 8855552
    s_add_u32 s10, s22, s30
    s_addc_u32 s11, s23, 0
LwM__14:
    ds_read_b32 v2, v3 offset:40
    s_waitcnt lgkmcnt(0)
    v_cmp_gt_u32 vcc, 8, v2
    s_cbranch_vccnz LwM__14
    ds_read_b128 v[104:107], v18 offset:0
    ds_read_b128 v[72:75], v18 offset:4096
    ds_read_b128 v[108:111], v18 offset:1024
    ds_read_b128 v[76:79], v18 offset:5120
    ds_read_b128 v[112:115], v18 offset:2048
    ds_read_b128 v[80:83], v18 offset:6144
    ds_read_b128 v[116:119], v18 offset:3072
    ds_read_b128 v[84:87], v18 offset:7168
    ds_read_b128 v[120:123], v20
    ds_read_b128 v[88:91], v20 offset:256
    s_waitcnt lgkmcnt(8)
    v_pk_add_f32 v[104:105], v[104:105], v[72:73]
    v_pk_add_f32 v[106:107], v[106:107], v[74:75]
    v_bfi_b32 v104, s35, v24, v104
    v_bfi_b32 v105, s35, v25, v105
    v_bfi_b32 v106, s35, v26, v106
    v_bfi_b32 v107, s35, v27, v107
    global_store_dwordx4 v19, v[104:107], s[22:23] offset:0 sc1
    s_waitcnt lgkmcnt(6)
    v_pk_add_f32 v[108:109], v[108:109], v[76:77]
    v_pk_add_f32 v[110:111], v[110:111], v[78:79]
    v_bfi_b32 v108, s35, v24, v108
    v_bfi_b32 v109, s35, v25, v109
    v_bfi_b32 v110, s35, v26, v110
    v_bfi_b32 v111, s35, v27, v111
    global_store_dwordx4 v19, v[108:111], s[22:23] offset:1024 sc1
    s_waitcnt lgkmcnt(4)
    v_pk_add_f32 v[112:113], v[112:113], v[80:81]
    v_pk_add_f32 v[114:115], v[114:115], v[82:83]
    v_bfi_b32 v112, s35, v24, v112
    v_bfi_b32 v113, s35, v25, v113
    v_bfi_b32 v114, s35, v26, v114
    v_bfi_b32 v115, s35, v27, v115
    global_store_dwordx4 v19, v[112:115], s[22:23] offset:2048 sc1
    s_waitcnt lgkmcnt(2)
    v_pk_add_f32 v[116:117], v[116:117], v[84:85]
    v_pk_add_f32 v[118:119], v[118:119], v[86:87]
    v_bfi_b32 v116, s35, v24, v116
    v_bfi_b32 v117, s35, v25, v117
    v_bfi_b32 v118, s35, v26, v118
    v_bfi_b32 v119, s35, v27, v119
    global_store_dwordx4 v19, v[116:119], s[22:23] offset:3072 sc1
    s_waitcnt lgkmcnt(0)
    v_pk_add_f32 v[120:121], v[120:121], v[88:89]
    v_pk_add_f32 v[122:123], v[122:123], v[90:91]
    v_bfi_b32 v120, s35, v24, v120
    v_bfi_b32 v121, s35, v25, v121
    v_bfi_b32 v122, s35, v26, v122
    v_bfi_b32 v123, s35, v27, v123
    s_mov_b64 exec, 0xffff
    global_store_dwordx4 v10, v[120:123], s[22:23] sc1
    s_mov_b64 exec, 0xff
    global_atomic_add v20, v13, v4, s[22:23] sc0 sc1
    s_mov_b64 exec, -1
    s_waitcnt vmcnt(0)
    v_readfirstlane_b32 s31, v20
    s_nop 0
    s_cmp_ge_u32 s31, 31
    s_cbranch_scc1 Lfk_ok
Lfk:
    s_mov_b32 s31, 0
    s_atomic_or s31, s[10:11], 0 glc
    s_waitcnt lgkmcnt(0)
    s_cmp_ge_u32 s31, 32
    s_cbranch_scc1 Lfk_ok
    s_cmp_eq_u32 s32, 0
    s_cbranch_scc1 Lfk_ok
    s_sub_u32 s32, s32, 1
    s_sleep 3
    s_branch Lfk
Lfk_ok:
    v_mov_b32 v18, v16
    global_load_dwordx4 v[152:155], v18, s[22:23] sc1
    v_add_u32 v18, 34816, v18
    global_load_dwordx4 v[156:159], v18, s[22:23] sc1
    v_add_u32 v18, 34816, v18
    global_load_dwordx4 v[160:163], v18, s[22:23] sc1
    v_add_u32 v18, 34816, v18
    global_load_dwordx4 v[164:167], v18, s[22:23] sc1
    s_cmp_eq_u32 s33, 0
    s_cbranch_scc1 Lz1
    v_mov_b32 v18, v17
    global_load_dwordx4 v[136:139], v18, s[22:23] sc1
    v_add_u32 v18, 34816, v18
    global_load_dwordx4 v[140:143], v18, s[22:23] sc1
    v_add_u32 v18, 34816, v18
    global_load_dwordx4 v[144:147], v18, s[22:23] sc1
    v_add_u32 v18, 34816, v18
    global_load_dwordx4 v[148:151], v18, s[22:23] sc1
Lz1:
    v_mul_u32_u24 v1, 126, v7
    v_sub_u32 v14, v14, v1
    v_sub_u32 v15, v15, v1
    s_waitcnt vmcnt(0)
Lred:
    v_xor_b32 v1, v152, v24
    v_bitop3_b32 v1, v1, v153, v25 bitop3:0xf6
    v_bitop3_b32 v1, v1, v154, v26 bitop3:0xf6
    v_bitop3_b32 v1, v1, v155, v27 bitop3:0xf6
    v_bitop3_b32 v1, v1, v156, v24 bitop3:0xf6
    v_bitop3_b32 v1, v1, v157, v25 bitop3:0xf6
    v_bitop3_b32 v1, v1, v158, v26 bitop3:0xf6
    v_bitop3_b32 v1, v1, v159, v27 bitop3:0xf6
    v_bitop3_b32 v1, v1, v160, v24 bitop3:0xf6
    v_bitop3_b32 v1, v1, v161, v25 bitop3:0xf6
    v_bitop3_b32 v1, v1, v162, v26 bitop3:0xf6
    v_bitop3_b32 v1, v1, v163, v27 bitop3:0xf6
    v_bitop3_b32 v1, v1, v164, v24 bitop3:0xf6
    v_bitop3_b32 v1, v1, v165, v25 bitop3:0xf6
    v_bitop3_b32 v1, v1, v166, v26 bitop3:0xf6
    v_bitop3_b32 v1, v1, v167, v27 bitop3:0xf6
    v_and_b32 v1, 0xff, v1
    v_cmp_ne_u32 vcc, 0, v1
    s_cbranch_vccz Lred_ok
    s_cmp_eq_u32 s32, 0
    s_cbranch_scc1 Lred_ok
    s_sub_u32 s32, s32, 1
    s_sleep 4
    s_mov_b64 exec, vcc
    v_mov_b32 v18, v16
    global_load_dwordx4 v[152:155], v18, s[22:23] sc1
    v_add_u32 v18, 34816, v18
    global_load_dwordx4 v[156:159], v18, s[22:23] sc1
    v_add_u32 v18, 34816, v18
    global_load_dwordx4 v[160:163], v18, s[22:23] sc1
    v_add_u32 v18, 34816, v18
    global_load_dwordx4 v[164:167], v18, s[22:23] sc1
    s_mov_b64 exec, -1
    s_waitcnt vmcnt(0)
    s_branch Lred
Lred_ok:
    v_pk_add_f32 v[152:153], v[152:153], v[160:161]
    v_pk_add_f32 v[154:155], v[154:155], v[162:163]
    v_pk_add_f32 v[156:157], v[156:157], v[164:165]
    v_pk_add_f32 v[158:159], v[158:159], v[166:167]
    v_pk_add_f32 v[152:153], v[152:153], v[156:157]
    v_pk_add_f32 v[154:155], v[154:155], v[158:159]
    s_nop 0
    v_add_f32_dpp v152, v152, v152 row_ror:8 row_mask:0xf bank_mask:0xf
    v_add_f32_dpp v153, v153, v153 row_ror:8 row_mask:0xf bank_mask:0xf
    v_add_f32_dpp v154, v154, v154 row_ror:8 row_mask:0xf bank_mask:0xf
    v_add_f32_dpp v155, v155, v155 row_ror:8 row_mask:0xf bank_mask:0xf
    v_permlane16_swap_b32 v152, v153
    s_nop 0
    v_permlane16_swap_b32 v154, v155
    v_add_f32 v152, v152, v153
    v_add_f32 v154, v154, v155
    s_nop 1
    v_permlane32_swap_b32 v152, v154
    v_add_f32 v152, v152, v154
    v_cvt_pk_bf16_f32 v152, v152, v152
    s_mov_b32 exec_lo, 0x00ff00ff
    s_mov_b32 exec_hi, 0x00ff00ff
    global_store_short v14, v152, s[22:23] sc1
    s_mov_b64 exec, -1
    s_cmp_eq_u32 s33, 0
    s_cbranch_scc1 Lz2
Lrez:
    v_xor_b32 v1, v136, v24
    v_bitop3_b32 v1, v1, v137, v25 bitop3:0xf6
    v_bitop3_b32 v1, v1, v138, v26 bitop3:0xf6
    v_bitop3_b32 v1, v1, v139, v27 bitop3:0xf6
    v_bitop3_b32 v1, v1, v140, v24 bitop3:0xf6
    v_bitop3_b32 v1, v1, v141, v25 bitop3:0xf6
    v_bitop3_b32 v1, v1, v142, v26 bitop3:0xf6
    v_bitop3_b32 v1, v1, v143, v27 bitop3:0xf6
    v_bitop3_b32 v1, v1, v144, v24 bitop3:0xf6
    v_bitop3_b32 v1, v1, v145, v25 bitop3:0xf6
    v_bitop3_b32 v1, v1, v146, v26 bitop3:0xf6
    v_bitop3_b32 v1, v1, v147, v27 bitop3:0xf6
    v_bitop3_b32 v1, v1, v148, v24 bitop3:0xf6
    v_bitop3_b32 v1, v1, v149, v25 bitop3:0xf6
    v_bitop3_b32 v1, v1, v150, v26 bitop3:0xf6
    v_bitop3_b32 v1, v1, v151, v27 bitop3:0xf6
    v_and_b32 v1, 0xff, v1
    v_cmp_ne_u32 vcc, 0, v1
    s_cbranch_vccz Lrez_ok
    s_cmp_eq_u32 s32, 0
    s_cbranch_scc1 Lrez_ok
    s_sub_u32 s32, s32, 1
    s_sleep 4
    s_mov_b64 exec, vcc
    v_mov_b32 v18, v17
    global_load_dwordx4 v[136:139], v18, s[22:23] sc1
    v_add_u32 v18, 34816, v18
    global_load_dwordx4 v[140:143], v18, s[22:23] sc1
    v_add_u32 v18, 34816, v18
    global_load_dwordx4 v[144:147], v18, s[22:23] sc1
    v_add_u32 v18, 34816, v18
    global_load_dwordx4 v[148:151], v18, s[22:23] sc1
    s_mov_b64 exec, -1
    s_waitcnt vmcnt(0)
    s_branch Lrez
Lrez_ok:
    v_pk_add_f32 v[136:137], v[136:137], v[144:145]
    v_pk_add_f32 v[138:139], v[138:139], v[146:147]
    v_pk_add_f32 v[140:141], v[140:141], v[148:149]
    v_pk_add_f32 v[142:143], v[142:143], v[150:151]
    v_pk_add_f32 v[136:137], v[136:137], v[140:141]
    v_pk_add_f32 v[138:139], v[138:139], v[142:143]
    s_nop 0
    v_add_f32_dpp v136, v136, v136 row_ror:8 row_mask:0xf bank_mask:0xf
    v_add_f32_dpp v137, v137, v137 row_ror:8 row_mask:0xf bank_mask:0xf
    v_add_f32_dpp v138, v138, v138 row_ror:8 row_mask:0xf bank_mask:0xf
    v_add_f32_dpp v139, v139, v139 row_ror:8 row_mask:0xf bank_mask:0xf
    v_permlane16_swap_b32 v136, v137
    s_nop 0
    v_permlane16_swap_b32 v138, v139
    v_add_f32 v136, v136, v137
    v_add_f32 v138, v138, v139
    s_nop 1
    v_permlane32_swap_b32 v136, v138
    v_add_f32 v136, v136, v138
    v_cvt_pk_bf16_f32 v136, v136, v136
    s_mov_b32 exec_lo, 0x00ff00ff
    s_mov_b32 exec_hi, 0x00ff00ff
    global_store_short v15, v136, s[22:23] sc1
    s_mov_b64 exec, -1
Lz2:
    s_lshr_b32 s31, s2, 5
    s_lshl_b32 s30, s31, 7
    s_add_u32 s30, s30, 8848384
    s_add_u32 s10, s22, s30
    s_addc_u32 s11, s23, 0
    s_mov_b32 s31, 1
    s_atomic_add s31, s[10:11], 0 glc
    v_lshlrev_b32 v1, 7, v5
    v_add_u32 v1, 8871936, v1
    s_waitcnt lgkmcnt(0)
    s_cmp_lg_u32 s31, 31
    s_cbranch_scc1 Larr1_notlast
    global_atomic_add v1, v4, s[22:23] sc1
Larr1_notlast:
    s_branch LwB2__15f
LwB2__15:
    s_sleep 1
LwB2__15f:
    ds_read_b32 v2, v3 offset:32
    s_waitcnt lgkmcnt(0)
    v_cmp_gt_u32 vcc, 9, v2
    s_cbranch_vccnz LwB2__15
    v_bfe_u32 v18, v5, 4, 1
    v_xor_b32 v18, v18, v5
    v_lshlrev_b32 v18, 4, v18
    v_add_u32 v18, 8388608, v18
    s_mov_b32 m0, 139392
    s_and_b32 s31, s2, 63
    s_lshl_b32 s30, s31, 7
    s_add_u32 s30, s30, 8871936
    s_add_u32 s10, s22, s30
    s_addc_u32 s11, s23, 0
Lbk:
    s_mov_b32 s31, 0
    s_atomic_or s31, s[10:11], 0 glc
    s_waitcnt lgkmcnt(0)
    s_cmp_ge_u32 s31, 8
    s_cbranch_scc1 Lbk_ok
    s_cmp_eq_u32 s32, 0
    s_cbranch_scc1 Lbk_ok
    s_sub_u32 s32, s32, 1
    s_sleep 4
    s_branch Lbk
Lbk_ok:
    global_load_lds_dwordx4 v18, s[22:23] offset:0 sc1
    global_load_lds_dwordx4 v18, s[22:23] offset:1024 sc1
    global_load_lds_dwordx4 v18, s[22:23] offset:2048 sc1
    global_load_lds_dwordx4 v18, s[22:23] offset:3072 sc1
    s_add_u32 m0, m0, 4096
    v_add_u32 v18, 4096, v18
    global_load_lds_dwordx4 v18, s[22:23] offset:0 sc1
    global_load_lds_dwordx4 v18, s[22:23] offset:1024 sc1
    global_load_lds_dwordx4 v18, s[22:23] offset:2048 sc1
    global_load_lds_dwordx4 v18, s[22:23] offset:3072 sc1
    s_add_u32 m0, m0, 4096
    v_add_u32 v18, 4096, v18
    global_load_lds_dwordx4 v18, s[22:23] offset:0 sc1
    global_load_lds_dwordx4 v18, s[22:23] offset:1024 sc1
    global_load_lds_dwordx4 v18, s[22:23] offset:2048 sc1
    global_load_lds_dwordx4 v18, s[22:23] offset:3072 sc1
    s_add_u32 m0, m0, 4096
    v_add_u32 v18, 4096, v18
    global_load_lds_dwordx4 v18, s[22:23] offset:0 sc1
    global_load_lds_dwordx4 v18, s[22:23] offset:1024 sc1
    global_load_lds_dwordx4 v18, s[22:23] offset:2048 sc1
    global_load_lds_dwordx4 v18, s[22:23] offset:3072 sc1
    s_add_u32 m0, m0, 4096
    v_add_u32 v18, 4096, v18
    global_load_lds_dwordx4 v18, s[22:23] offset:0 sc1
    s_waitcnt vmcnt(0)
    s_mov_b64 exec, 1
    ds_add_u32 v3, v4 offset:8
    s_mov_b64 exec, -1
    s_endpgm
Laux1:
    v_add_u32 v1, 98304, v8
    ds_read_b128 v[22:25], v1 offset:10240
    ds_read_b128 v[26:29], v1 offset:11264
    ds_read_b128 v[30:33], v1 offset:12288
    ds_read_b128 v[34:37], v1 offset:13312
    ds_read_b128 v[38:41], v1 offset:14336
    ds_read_b128 v[42:45], v1 offset:15360
    v_lshrrev_b32 v1, 3, v5
    v_lshlrev_b32 v1, 6, v1
    v_and_b32 v2, 7, v5
    v_lshl_add_u32 v1, v2, 1, v1
    v_add_u32 v10, 162048, v1
    v_add_u32 v13, 8521728, v8
    s_mov_b32 s33, 0
    s_waitcnt lgkmcnt(0)
    s_barrier
    v_mov_b32 v1, 0
    global_load_dword v12, v1, s[20:21] sc1
    s_setprio 0
    v_cvt_f32_u32 v15, v6
    v_lshlrev_b32 v86, 2, v7
    v_cvt_f32_u32 v86, v86
    v_add_f32 v87, 1.0, v86
    v_add_f32 v88, 2.0, v86
    v_add_f32 v89, 2.0, v87
    v_mul_f32 v90, v86, v15
    v_mul_f32 v91, v87, v15
    v_mul_f32 v92, v88, v15
    v_mul_f32 v93, v89, v15
    v_cmp_gt_u32 vcc, 2, v7
    v_mul_f32 v1, 0x41b80000, v15
    v_sub_f32 v58, v1, v90
    v_sub_f32 v59, v1, v91
    v_sub_f32 v60, v1, v92
    v_sub_f32 v61, v1, v93
    v_cndmask_b32 v58, v58, v90, vcc
    v_cndmask_b32 v59, v59, v91, vcc
    v_cndmask_b32 v60, v60, v92, vcc
    v_cndmask_b32 v61, v61, v93, vcc
    v_mul_f32 v54, 0x3d800000, v58
    v_mul_f32 v55, 0x3d800000, v59
    v_mul_f32 v56, 0x3d800000, v60
    v_mul_f32 v57, 0x3d800000, v61
    v_cos_f32 v50, v54
    v_cos_f32 v51, v55
    v_cos_f32 v52, v56
    v_cos_f32 v53, v57
    v_sin_f32 v54, v54
    v_sin_f32 v55, v55
    v_sin_f32 v56, v56
    v_sin_f32 v57, v57
    v_bfrev_b32 v2, 1
    v_cndmask_b32_e64 v2, v2, 0, vcc
    v_cvt_pk_bf16_f32 v66, v50, -v54
    v_cvt_pk_bf16_f32 v67, v51, -v55
    v_cvt_pk_bf16_f32 v68, v52, -v56
    v_cvt_pk_bf16_f32 v69, v53, -v57
    v_cvt_pk_bf16_f32 v70, v54, v50
    v_cvt_pk_bf16_f32 v71, v55, v51
    v_cvt_pk_bf16_f32 v72, v56, v52
    v_cvt_pk_bf16_f32 v73, v57, v53
    v_cndmask_b32 v74, 0, v66, vcc
    v_cndmask_b32 v75, 0, v67, vcc
    v_cndmask_b32 v76, 0, v68, vcc
    v_cndmask_b32 v77, 0, v69, vcc
    v_xor_b32 v66, v66, v2
    v_xor_b32 v67, v67, v2
    v_xor_b32 v68, v68, v2
    v_xor_b32 v69, v69, v2
    v_xor_b32 v70, v70, v2
    v_xor_b32 v71, v71, v2
    v_xor_b32 v72, v72, v2
    v_xor_b32 v73, v73, v2
    v_mul_f32 v1, 0xc0f00000, v15
    v_add_f32 v58, v1, v90
    v_add_f32 v59, v1, v91
    v_add_f32 v60, v1, v92
    v_add_f32 v61, v1, v93
    v_mul_f32 v54, 0x3d800000, v58
    v_mul_f32 v55, 0x3d800000, v59
    v_mul_f32 v56, 0x3d800000, v60
    v_mul_f32 v57, 0x3d800000, v61
    v_cos_f32 v50, v54
    v_cos_f32 v51, v55
    v_cos_f32 v52, v56
    v_cos_f32 v53, v57
    v_sin_f32 v54, v54
    v_sin_f32 v55, v55
    v_sin_f32 v56, v56
    v_sin_f32 v57, v57
    v_cvt_pk_bf16_f32 v78, v50, -v54
    v_cvt_pk_bf16_f32 v79, v51, -v55
    v_cvt_pk_bf16_f32 v80, v52, -v56
    v_cvt_pk_bf16_f32 v81, v53, -v57
    v_cndmask_b32_e64 v78, v78, 0, vcc
    v_cndmask_b32_e64 v79, v79, 0, vcc
    v_cndmask_b32_e64 v80, v80, 0, vcc
    v_cndmask_b32_e64 v81, v81, 0, vcc
    v_fma_f32 v58, 0.5, v86, v90
    v_fma_f32 v59, 0.5, v87, v91
    v_fma_f32 v60, 0.5, v88, v92
    v_fma_f32 v61, 0.5, v89, v93
    v_mul_f32 v54, 0x3d800000, v58
    v_mul_f32 v55, 0x3d800000, v59
    v_mul_f32 v56, 0x3d800000, v60
    v_mul_f32 v57, 0x3d800000, v61
    v_cos_f32 v50, v54
    v_cos_f32 v51, v55
    v_cos_f32 v52, v56
    v_cos_f32 v53, v57
    v_sin_f32 v54, v54
    v_sin_f32 v55, v55
    v_sin_f32 v56, v56
    v_sin_f32 v57, v57
    v_cvt_pk_bf16_f32 v82, v50, -v54
    v_cvt_pk_bf16_f32 v83, v51, -v55
    v_cvt_pk_bf16_f32 v84, v52, -v56
    v_cvt_pk_bf16_f32 v85, v53, -v57
    v_lshlrev_b32 v1, 31, v6
    s_mov_b64 exec, 0xffff
    v_or_b32 v74, 0x3f003f00, v1
    v_mov_b32 v82, 0xbf803f80
    s_mov_b64 exec, -1
    s_setprio 3
    v_lshrrev_b32 v1, 3, v5
    v_xor_b32 v14, v1, v5
    v_bfe_u32 v14, v14, 2, 1
    v_lshl_add_u32 v1, v1, 4, v14
    v_mul_u32_u24 v14, 16512, v1
    v_and_b32 v1, 1, v5
    v_lshl_add_u32 v14, v1, 4, v14
    v_and_b32 v1, 2, v5
    v_lshl_add_u32 v14, v1, 5, v14
    s_lshl_b32 s30, s27, 6
    s_and_b32 s31, s27, 1
    s_lshl_b32 s31, s31, 5
    s_sub_u32 s30, s30, s31
    v_add_u32 v14, s30, v14
    v_lshrrev_b32 v1, 3, v5
    s_lshl_b32 s30, s29, 3
    v_add_u32 v1, s30, v1
    v_lshl_add_u32 v1, v1, 3, s28
    v_mul_u32_u24 v1, 514, v1
    v_and_b32 v1, -4, v1
    v_and_b32 v2, 7, v5
    v_min_u32 v2, 4, v2
    v_lshl_add_u32 v94, v2, 7, v1
    s_lshl_b32 s30, s29, 14
    s_and_b32 s31, s26, 4
    s_lshl_b32 s31, s31, 7
    s_add_u32 s30, s30, s31
    v_lshrrev_b32 v1, 2, v5
    v_lshlrev_b32 v1, 10, v1
    v_and_b32 v2, 3, v5
    v_lshl_add_u32 v1, v2, 7, v1
    v_add_u32 v95, s30, v1
    s_barrier
    s_waitcnt vmcnt(1)
    ds_write_b16 v10, v11
    v_lshrrev_b32 v1, 2, v5
    v_and_b32 v1, 7, v1
    v_lshlrev_b32 v1, 6, v1
    v_add_u32 v1, 162048, v1
    ds_read_b128 v[152:155], v1
    ds_read_b32 v48, v1 offset:16
    s_waitcnt lgkmcnt(0)
    v_lshlrev_b32 v1, 16, v152
    v_lshlrev_b32 v2, 16, v153
    v_add_f32 v156, v1, v2
    v_and_b32 v1, 0xffff0000, v152
    v_and_b32 v2, 0xffff0000, v153
    v_sub_f32 v157, v1, v2
    v_lshlrev_b32 v1, 16, v154
    v_lshlrev_b32 v2, 16, v155
    v_add_f32 v158, v1, v2
    v_and_b32 v1, 0xffff0000, v154
    v_and_b32 v2, 0xffff0000, v155
    v_sub_f32 v159, v1, v2
    v_add_f32 v1, v156, v158
    v_add_f32 v2, v157, v159
    v_mul_f32 v1, 0x3e800000, v1
    v_mul_f32 v2, 0x3e800000, v2
    v_cvt_pk_bf16_f32 v46, v1, v2
    v_sub_f32 v1, v156, v158
    v_sub_f32 v2, v157, v159
    v_mul_f32 v1, 0x3e800000, v1
    v_mul_f32 v2, 0x3e800000, v2
    v_cvt_pk_bf16_f32 v47, v1, v2
    v_xor_b32 v48, 0x80000000, v48
    v_mov_b32 v49, 0
    v_lshrrev_b32 v1, 2, v5
    v_lshlrev_b32 v1, 14, v1
    v_and_b32 v2, 3, v5
    v_lshl_add_u32 v1, v2, 4, v1
    s_lshl_b32 s30, s27, 6
    s_add_u32 s30, s30, 9043968
    v_add_u32 v1, s30, v1
    s_mov_b32 exec_hi, 0
    global_store_dwordx4 v1, v[46:49], s[22:23] sc1
    s_mov_b64 exec, -1
    s_barrier
    s_branch Lnv1_first
Lnv1:
    v_mov_b32 v1, 0
    global_load_dword v12, v1, s[20:21] sc1
Lnv1_first:
    s_waitcnt vmcnt(0)
    v_cmp_eq_u32 vcc, 0, v12
    s_cbranch_vccz Lnv1_ok
    s_cmp_eq_u32 s32, 0
    s_cbranch_scc1 Lnv1_ok
    s_sub_u32 s32, s32, 1
    s_sleep 4
    s_branch Lnv1
Lnv1_ok:
    s_barrier
    s_barrier
    s_barrier
    s_cmp_lg_u32 s29, 0
    s_cbranch_scc1 Ltry_skip
    v_add_u32 v1, 8519680, v8
    global_load_dword v18, v1, s[22:23] offset:0 sc1
    global_load_dword v19, v1, s[22:23] offset:1024 sc1
    global_load_dword v20, v1, s[22:23] offset:2048 sc1
    global_load_dword v21, v1, s[22:23] offset:3072 sc1
Ltry_skip:
    s_barrier
    s_cmp_lg_u32 s29, 0
    s_cbranch_scc1 Ltry2_skip
    s_waitcnt vmcnt(0)
    v_xor_b32 v1, v12, v18
    v_bitop3_b32 v1, v1, v12, v19 bitop3:0xf6
    v_bitop3_b32 v1, v1, v12, v20 bitop3:0xf6
    v_bitop3_b32 v1, v1, v12, v21 bitop3:0xf6
    v_cmp_ne_u32 vcc, 0, v1
    s_cbranch_vccnz Ltry2_skip
    s_mov_b32 s33, 1
    s_lshl_b32 s31, s28, 14
    s_add_u32 s31, s31, 9043968
    v_lshl_add_u32 v1, v7, 6, v6
    v_lshl_add_u32 v1, v1, 6, s31
    global_load_dwordx4 v[152:155], v1, s[22:23] offset:0 sc1
    global_load_dwordx4 v[156:159], v1, s[22:23] offset:1024 sc1
    global_load_dwordx4 v[160:163], v1, s[22:23] offset:2048 sc1
    global_load_dwordx4 v[164:167], v1, s[22:23] offset:3072 sc1
Ltry2_skip:
    s_barrier
    global_load_dword v16, v13, s[22:23] offset:0 sc1
    global_load_dword v17, v13, s[22:23] offset:1024 sc1
    s_barrier
    s_branch Lf11_first
Lf11:
    global_load_dword v16, v13, s[22:23] offset:0 sc1
    global_load_dword v17, v13, s[22:23] offset:1024 sc1
Lf11_first:
    s_waitcnt vmcnt(0)
    v_xor_b32 v1, v12, v16
    v_bitop3_b32 v1, v1, v12, v17 bitop3:0xf6
    v_cmp_ne_u32 vcc, 0, v1
    s_cbranch_vccz Lf11_ok
    s_cmp_eq_u32 s32, 0
    s_cbranch_scc1 Lf11_ok
    s_sub_u32 s32, s32, 1
    s_sleep 8
    s_branch Lf11
Lf11_ok:
    s_mov_b64 exec, 1
    ds_add_u32 v3, v4 offset:24
    s_mov_b64 exec, -1
    s_branch LwF__16f
LwF__16:
    s_sleep 1
LwF__16f:
    ds_read_b32 v2, v3 offset:24
    s_waitcnt lgkmcnt(0)
    v_cmp_gt_u32 vcc, 2, v2
    s_cbranch_vccnz LwF__16
    s_cmp_lg_u32 s29, 0
    s_cbranch_scc1 Lspc_skip
    s_cmp_lg_u32 s33, 0
    s_cbranch_scc1 Lspl_skip
    s_lshl_b32 s31, s28, 14
    s_add_u32 s31, s31, 9043968
    v_lshl_add_u32 v1, v7, 6, v6
    v_lshl_add_u32 v1, v1, 6, s31
    global_load_dwordx4 v[152:155], v1, s[22:23] offset:0 sc1
    global_load_dwordx4 v[156:159], v1, s[22:23] offset:1024 sc1
    global_load_dwordx4 v[160:163], v1, s[22:23] offset:2048 sc1
    global_load_dwordx4 v[164:167], v1, s[22:23] offset:3072 sc1
Lspl_skip:
    s_waitcnt vmcnt(0)
    v_mov_b32 v46, v154
    v_mov_b32 v47, v158
    v_mov_b32 v48, v162
    v_mov_b32 v49, v166
    s_nop 1
    v_mfma_f32_16x16x32_bf16 v[50:53], v[46:49], v[22:25], 0
    v_mfma_f32_16x16x32_bf16 v[54:57], v[46:49], v[26:29], 0
    v_lshlrev_b32 v58, 16, v152
    v_and_b32 v62, 0xffff0000, v152
    v_lshlrev_b32 v59, 16, v156
    v_and_b32 v63, 0xffff0000, v156
    v_lshlrev_b32 v60, 16, v160
    v_and_b32 v64, 0xffff0000, v160
    v_lshlrev_b32 v61, 16, v164
    v_and_b32 v65, 0xffff0000, v164
    v_pk_mul_f32 v[148:149], v[50:51], v[30:31]
    v_pk_mul_f32 v[150:151], v[52:53], v[32:33]
    v_pk_mul_f32 v[144:145], v[50:51], v[34:35] neg_lo:[1,0] neg_hi:[1,0]
    v_pk_mul_f32 v[146:147], v[52:53], v[36:37] neg_lo:[1,0] neg_hi:[1,0]
    v_pk_fma_f32 v[148:149], v[54:55], v[34:35], v[148:149]
    v_pk_fma_f32 v[144:145], v[54:55], v[30:31], v[144:145]
    v_pk_fma_f32 v[150:151], v[56:57], v[36:37], v[150:151]
    v_pk_fma_f32 v[146:147], v[56:57], v[32:33], v[146:147]
    v_cvt_pk_bf16_f32 v46, v148, v144
    v_cvt_pk_bf16_f32 v47, v149, v145
    v_cvt_pk_bf16_f32 v48, v150, v146
    v_cvt_pk_bf16_f32 v49, v151, v147
    s_nop 1
    v_mfma_f32_16x16x32_bf16 v[50:53], v[38:41], v[46:49], 0
    v_mfma_f32_16x16x32_bf16 v[54:57], v[42:45], v[46:49], 0
    v_add_u32 v1, 156928, v8
    ds_write_b128 v1, v[58:61]
    ds_write_b128 v1, v[62:65] offset:1024
    v_lshlrev_b32 v22, 16, v153
    v_and_b32 v26, 0xffff0000, v153
    v_lshlrev_b32 v23, 16, v157
    v_and_b32 v27, 0xffff0000, v157
    v_lshlrev_b32 v24, 16, v161
    v_and_b32 v28, 0xffff0000, v161
    v_lshlrev_b32 v25, 16, v165
    v_and_b32 v29, 0xffff0000, v165
    v_mul_f32 v30, v50, v22
    v_mul_f32 v34, v54, v22
    v_mul_f32 v31, v51, v23
    v_mul_f32 v35, v55, v23
    v_mul_f32 v32, v52, v24
    v_mul_f32 v36, v56, v24
    v_mul_f32 v33, v53, v25
    v_mul_f32 v37, v57, v25
    v_fma_f32 v30, -v54, v26, v30
    v_fma_f32 v34, v50, v26, v34
    v_fma_f32 v31, -v55, v27, v31
    v_fma_f32 v35, v51, v27, v35
    v_fma_f32 v32, -v56, v28, v32
    v_fma_f32 v36, v52, v28, v36
    v_fma_f32 v33, -v57, v29, v33
    v_fma_f32 v37, v53, v29, v37
    ds_write_b128 v1, v[30:33] offset:2048
    ds_write_b128 v1, v[34:37] offset:3072
Lspc_skip:
    s_mov_b64 exec, 1
    ds_add_u32 v3, v4 offset:28
    s_mov_b64 exec, -1
    s_lshl_b32 s31, s28, 4
    s_lshr_b32 s30, s29, 1
    s_add_u32 s31, s31, s30
    s_lshl_b32 s30, s31, 7
    s_add_u32 s30, s30, 8880128
    s_add_u32 s10, s22, s30
    s_addc_u32 s11, s23, 0
    s_branch LwB1__17f
LwB1__17:
    s_sleep 2
LwB1__17f:
    ds_read_b32 v2, v3 offset:28
    s_waitcnt lgkmcnt(0)
    v_cmp_gt_u32 vcc, 3, v2
    s_cbranch_vccnz LwB1__17
Lpb:
    s_mov_b32 s31, 0
    s_atomic_or s31, s[10:11], 0 glc
    s_waitcnt lgkmcnt(0)
    s_cmp_ge_u32 s31, 4
    s_cbranch_scc1 Lpb_ok
    s_cmp_eq_u32 s32, 0
    s_cbranch_scc1 Lpb_ok
    s_sub_u32 s32, s32, 1
    s_sleep 2
    s_branch Lpb
Lpb_ok:
    s_mov_b64 exec, 1
    ds_add_u32 v3, v4 offset:32
    s_mov_b64 exec, -1
    s_branch LwS__18f
LwS__18:
    s_sleep 1
LwS__18f:
    ds_read_b32 v2, v3 offset:36
    s_waitcnt lgkmcnt(0)
    v_cmp_gt_u32 vcc, 8, v2
    s_cbranch_vccnz LwS__18
    v_add_u32 v15, 156928, v8
    ds_write_b128 v15, v[66:69] offset:0
    ds_write_b128 v15, v[70:73] offset:1024
    ds_write_b128 v15, v[74:77] offset:2048
    ds_write_b128 v15, v[78:81] offset:3072
    ds_write_b128 v15, v[82:85] offset:4096
    s_mov_b64 exec, 1
    ds_add_u32 v3, v4 offset:56
    s_mov_b64 exec, -1
    s_mov_b32 m0, 131072
    v_add_u32 v15, 131072, v8
    s_and_b32 s31, s2, 63
    s_lshl_b32 s30, s31, 7
    s_add_u32 s30, s30, 8863744
    s_add_u32 s10, s22, s30
    s_addc_u32 s11, s23, 0
Lbr:
    s_mov_b32 s31, 0
    s_atomic_or s31, s[10:11], 0 glc
    s_waitcnt lgkmcnt(0)
    s_cmp_ge_u32 s31, 8
    s_cbranch_scc1 Lbr_ok
    s_cmp_eq_u32 s32, 0
    s_cbranch_scc1 Lbr_ok
    s_sub_u32 s32, s32, 1
    s_sleep 4
    s_branch Lbr
Lbr_ok:
    global_load_lds_dwordx4 v14, s[22:23] sc1
    s_add_u32 m0, m0, 1024
    v_add_u32 v14, 33024, v14
    global_load_lds_dwordx4 v14, s[22:23] sc1
    s_add_u32 m0, m0, 1024
    v_add_u32 v14, 33024, v14
    global_load_lds_dwordx4 v14, s[22:23] sc1
    s_add_u32 m0, m0, 1024
    v_add_u32 v14, 33024, v14
    global_load_lds_dwordx4 v14, s[22:23] sc1
    s_add_u32 m0, m0, 1024
    v_add_u32 v14, 33024, v14
    global_load_lds_dwordx4 v14, s[22:23] sc1
    s_add_u32 m0, m0, 1024
    v_add_u32 v14, 33024, v14
    global_load_lds_dwordx4 v14, s[22:23] sc1
    s_add_u32 m0, m0, 1024
    v_add_u32 v14, 33024, v14
    global_load_lds_dwordx4 v14, s[22:23] sc1
    s_add_u32 m0, m0, 1024
    v_add_u32 v14, 33024, v14
    global_load_lds_dwordx4 v14, s[22:23] sc1
    s_lshr_b32 s31, s27, 1
    s_lshl_b32 s30, s31, 7
    s_add_u32 s30, s30, 8896512
    s_add_u32 s10, s22, s30
    s_addc_u32 s11, s23, 0
    s_waitcnt vmcnt(0)
    ds_read2st64_b32 v[152:153], v15 offset0:0 offset1:4
    ds_read2st64_b32 v[154:155], v15 offset0:8 offset1:12
    ds_read2st64_b32 v[156:157], v15 offset0:16 offset1:20
    ds_read2st64_b32 v[158:159], v15 offset0:24 offset1:28
    s_mov_b64 exec, 1
    ds_add_u32 v3, v4 offset:4
    s_mov_b64 exec, -1
    s_waitcnt lgkmcnt(0)
    v_bitop3_b32 v1, v152, v153, v154 bitop3:0x80
    v_bitop3_b32 v1, v1, v155, v156 bitop3:0x80
    v_bitop3_b32 v1, v1, v157, v158 bitop3:0x80
    v_bitop3_b32 v1, v1, v159, 1 bitop3:0x80
    v_cmp_eq_u32 vcc, 0, v1
    s_cbranch_vccz Lpc_go
LwC__19:
    ds_read_b32 v2, v3 offset:48
    s_waitcnt lgkmcnt(0)
    v_cmp_gt_u32 vcc, 8, v2
    s_cbranch_vccnz LwC__19
Lpc_go:
    s_mov_b32 s31, 1
    s_atomic_add s31, s[10:11], 0 glc
    s_waitcnt lgkmcnt(0)
    s_cmp_ge_u32 s31, 1
    s_cbranch_scc1 Lpc_ok
Lpc:
    s_mov_b32 s31, 0
    s_atomic_or s31, s[10:11], 0 glc
    s_waitcnt lgkmcnt(0)
    s_cmp_ge_u32 s31, 2
    s_cbranch_scc1 Lpc_ok
    s_cmp_eq_u32 s32, 0
    s_cbranch_scc1 Lpc_ok
    s_sub_u32 s32, s32, 1
    s_sleep 0
    s_branch Lpc
Lpc_ok:
    s_mov_b64 exec, 1
    ds_add_u32 v3, v4 offset:52
    s_mov_b64 exec, -1
Lend:
    s_endpgm
Lcode_end:
.section .rodata,"a"
.p2align 6
.amdhsa_kernel gated_mix__spectral_gfnet__linear_attn_block__prompt_kernel
  .amdhsa_next_free_vgpr 168
  .amdhsa_next_free_sgpr 102
  .amdhsa_accum_offset 168
  .amdhsa_group_segment_fixed_size 0
  .amdhsa_kernarg_size 80
  .amdhsa_user_sgpr_count 2
  .amdhsa_user_sgpr_kernarg_segment_ptr 1
  .amdhsa_system_sgpr_workgroup_id_x 1
.end_amdhsa_kernel
.text
```
